```python
import torch

def _softmax(x, axis=-1):
    return torch.softmax(x, dim=axis)
def _gelu(x):
    return torch.nn.functional.gelu(x, approximate="tanh")
def _silu(x):
    return torch.nn.functional.silu(x)
def _sigmoid(x):
    return torch.sigmoid(x)
def _layernorm(x, axis=-1, eps=1e-5):
    m = x.mean(dim=axis, keepdim=True)
    v = x.var(dim=axis, keepdim=True, unbiased=False)
    return (x - m) / torch.sqrt(v + eps)
def _scatter_add(tgt, idx, src, axis=0):
    return tgt.clone().index_add_(axis, idx, src)
def _segment_sum(src, seg, n):
    out = torch.zeros((n,) + src.shape[1:], dtype=src.dtype)
    return out.index_add_(0, seg, src)
def _pad(x, pw):
    flat = tuple(v for pair in reversed(pw) for v in pair)
    return torch.nn.functional.pad(x, flat)

kernel_name = 'gated_mix__softmax_full_mha__dense_activation_gelu__prompt'

def setup_inputs():

    _w = (lambda a: (lambda t: t.to(torch.bfloat16) if t.is_floating_point() else t)(torch.as_tensor(a)))
    def _A_setup():
        B, S, D = 1, 2048, 512
        return {
            "x": _w((lambda *s: torch.randn(*s, dtype=torch.bfloat16) * 0.05)(B, S, D)),
            "wqkv": _w((lambda *s: torch.randn(*s, dtype=torch.bfloat16) * 0.8)(D, 3 * D)),
            "wo": _w((lambda *s: torch.randn(*s, dtype=torch.bfloat16) * 0.05)(D, D)),
        }
    _A_in = _A_setup()

    def _B_setup():
        B, S, D, F = 1, 2048, 512, 1792
        return {
            "x": _w((lambda *s: torch.randn(*s, dtype=torch.bfloat16) * 0.05)(B, S, D)),
            "w1": _w((lambda *s: torch.randn(*s, dtype=torch.bfloat16) * 3.2)(D, F) * (D ** -0.5)),
            "b1": _w((lambda *s: torch.randn(*s, dtype=torch.bfloat16) * 3.2)(F) * 0.01),
            "w2": _w((lambda *s: torch.randn(*s, dtype=torch.bfloat16) * 0.8)(F, D) * (F ** -0.5)),
            "b2": _w((lambda *s: torch.randn(*s, dtype=torch.bfloat16) * 1.6)(D) * 0.01),
        }
    _B_in = _B_setup()

    return {
        "A_x": _A_in["x"],
        "A_wqkv": _A_in["wqkv"],
        "A_wo": _A_in["wo"],
        "B_x": _B_in["x"],
        "B_w1": _B_in["w1"],
        "B_b1": _B_in["b1"],
        "B_w2": _B_in["w2"],
        "B_b2": _B_in["b2"],
        "gate_w": _w((lambda *s: torch.randn(*s, dtype=torch.bfloat16) * 0.05)(512) * 16.0),
    }

def reference(A_x, A_wqkv, A_wo, B_x, B_w1, B_b1, B_w2, B_b2, gate_w):
    def _A_ref(x, wqkv, wo):
        B, S, D = x.shape
        H = 32; Dh = D // H
        qkv = (lambda x, *d: x.permute(*d))((x @ wqkv).reshape(B, S, 3, H, Dh), 2, 0, 3, 1, 4)
        q, k, v = qkv[0], qkv[1], qkv[2]
        scale = Dh ** -0.5
        scores = torch.einsum("bhqd,bhkd->bhqk", q, k) * scale
        p = _softmax(scores, axis=-1)
        o = torch.einsum("bhqk,bhkd->bhqd", p, v)
        return (lambda x, *d: x.permute(*d))(o, 0, 2, 1, 3).reshape(B, S, D) @ wo

    def _B_ref(x, w1, b1, w2, b2):
        h = torch.einsum("bsd,df->bsf", x, w1) + b1
        h = _gelu(h)
        return torch.einsum("bsf,fd->bsd", h, w2) + b2

    x = A_x
    g = _sigmoid((x * gate_w).sum(-1, keepdims=True))
    a = _A_ref(x, A_wqkv, A_wo)
    b = _B_ref(x, B_w1, B_b1, B_w2, B_b2)
    return g * a + (1 - g) * b
```

```asm
; @launch grid=(256,1,1) block=(768,1,1) lds=163840
.amdgcn_target "amdgcn-amd-amdhsa--gfx950"
.text
.globl gated_mix__softmax_full_mha__dense_activation_gelu__prompt_kernel
.p2align 8
.type gated_mix__softmax_full_mha__dense_activation_gelu__prompt_kernel,@function
gated_mix__softmax_full_mha__dense_activation_gelu__prompt_kernel:
    s_cmpk_ge_u32 s2, 256
    s_cbranch_scc1 L_end
    s_load_dwordx16 s[16:31], s[0:1], 0
    s_load_dwordx8 s[32:39], s[0:1], 64
    v_lshrrev_b32 v2, 6, v0
    v_and_b32 v1, 63, v0
    v_readfirstlane_b32 s3, v2
    s_and_b32 s7, s2, 7
    s_lshr_b32 s8, s2, 3
    s_lshr_b32 s4, s7, 1
    s_lshl_b32 s4, s4, 3
    s_and_b32 s9, s8, 7
    s_add_u32 s4, s4, s9
    s_and_b32 s5, s7, 1
    s_lshr_b32 s10, s8, 3
    s_lshl2_add_u32 s5, s5, s10
    s_lshl_b32 s66, s7, 2
    s_add_u32 s66, s66, s10
    s_mov_b32 s67, s9
    s_add_u32 s6, s9, s10
    s_and_b32 s6, s6, 3
    s_lshl_b32 s6, s6, 1
    v_and_b32 v3, 31, v1
    v_lshrrev_b32 v4, 5, v1
    s_cmp_lt_u32 s3, 4
    s_cbranch_scc1 L_A
    s_cmp_lt_u32 s3, 8
    s_cbranch_scc1 L_B
    s_sub_u32 s7, s3, 8
    v_lshrrev_b32 v5, 3, v1
    v_lshlrev_b32 v5, 10, v5
    v_and_b32 v6, 7, v1
    v_lshrrev_b32 v7, 4, v1
    v_xor_b32 v7, v6, v7
    v_lshl_add_u32 v8, v7, 4, v5
    v_xor_b32 v7, 4, v7
    v_lshl_add_u32 v9, v7, 4, v5
    v_add_u32 v9, 7168, v9
    v_lshrrev_b32 v5, 3, v1
    v_mul_u32_u24 v10, 3072, v5
    v_bfe_u32 v7, v1, 4, 1
    v_lshlrev_b32 v7, 2, v7
    v_xor_b32 v7, v6, v7
    v_lshl_add_u32 v10, v7, 4, v10
    s_lshl_b32 s9, s6, 3
    v_add_u32 v5, s9, v1
    v_and_b32 v5, 63, v5
    v_lshlrev_b32 v11, 4, v5
    s_lshl_b32 s10, s4, 16
    s_lshl_b32 s9, s7, 14
    s_add_u32 s10, s10, s9
    s_mul_i32 s11, s7, 24576
    s_lshl_b32 s9, s5, 7
    s_add_u32 s11, s11, s9
    s_lshl_b32 s13, s7, 11
    s_mul_i32 s14, s7, 3072
    s_waitcnt lgkmcnt(0)
    s_mov_b32 s40, s16
    s_and_b32 s41, s17, 0xffff
    s_mov_b32 s42, 2097152
    s_mov_b32 s43, 0x00020000
    s_mov_b32 s44, s18
    s_and_b32 s45, s19, 0xffff
    s_mov_b32 s46, 1572864
    s_mov_b32 s47, 0x00020000
    s_add_u32 s60, s6, 0
    s_and_b32 s60, s60, 7
    s_lshl_b32 s60, s60, 7
    s_add_u32 m0, s13, 0
    s_add_u32 s60, s60, s10
    buffer_load_dwordx4 v8, s[40:43], s60 offen offset:0 lds
    buffer_load_dwordx4 v9, s[40:43], s60 offen offset:1024 lds
    s_mov_b32 s52, s32
    s_and_b32 s53, s33, 0xffff
    s_mov_b32 s54, 1024
    s_mov_b32 s55, 0x00020000
    s_mov_b32 m0, 155648
    s_nop 0
    buffer_load_dwordx4 v11, s[52:55], 0 offen lds
    s_lshl_b32 s61, s6, 1
    s_add_u32 s61, s61, 0
    s_and_b32 s61, s61, 15
    s_mul_i32 s61, s61, 98304
    s_add_u32 m0, s14, 90112
    s_add_u32 s61, s61, s11
    buffer_load_dwordx4 v10, s[44:47], s61 offen offset:0 lds
    buffer_load_dwordx4 v10, s[44:47], s61 offen offset:1024 lds
    buffer_load_dwordx4 v10, s[44:47], s61 offen offset:2048 lds
    s_lshl_b32 s61, s6, 1
    s_add_u32 s61, s61, 1
    s_and_b32 s61, s61, 15
    s_mul_i32 s61, s61, 98304
    s_add_u32 m0, s14, 102400
    s_add_u32 s61, s61, s11
    buffer_load_dwordx4 v10, s[44:47], s61 offen offset:0 lds
    buffer_load_dwordx4 v10, s[44:47], s61 offen offset:1024 lds
    buffer_load_dwordx4 v10, s[44:47], s61 offen offset:2048 lds
    s_add_u32 s60, s6, 1
    s_and_b32 s60, s60, 7
    s_lshl_b32 s60, s60, 7
    s_add_u32 m0, s13, 8192
    s_add_u32 s60, s60, s10
    buffer_load_dwordx4 v8, s[40:43], s60 offen offset:0 lds
    buffer_load_dwordx4 v9, s[40:43], s60 offen offset:1024 lds
    s_lshl_b32 s61, s6, 1
    s_add_u32 s61, s61, 2
    s_and_b32 s61, s61, 15
    s_mul_i32 s61, s61, 98304
    s_add_u32 m0, s14, 114688
    s_add_u32 s61, s61, s11
    buffer_load_dwordx4 v10, s[44:47], s61 offen offset:0 lds
    buffer_load_dwordx4 v10, s[44:47], s61 offen offset:1024 lds
    buffer_load_dwordx4 v10, s[44:47], s61 offen offset:2048 lds
    s_lshl_b32 s61, s6, 1
    s_add_u32 s61, s61, 3
    s_and_b32 s61, s61, 15
    s_mul_i32 s61, s61, 98304
    s_add_u32 m0, s14, 65536
    s_add_u32 s61, s61, s11
    buffer_load_dwordx4 v10, s[44:47], s61 offen offset:0 lds
    buffer_load_dwordx4 v10, s[44:47], s61 offen offset:1024 lds
    buffer_load_dwordx4 v10, s[44:47], s61 offen offset:2048 lds
    s_mov_b32 s52, s26
    s_and_b32 s53, s27, 0xffff
    s_mov_b32 s54, 3584
    s_mov_b32 s55, 0x00020000
    s_mul_i32 s9, s5, 448
    s_and_b32 s8, s5, 1
    s_lshl_b32 s8, s8, 6
    s_add_u32 s9, s9, s8
    v_lshlrev_b32 v11, 4, v1
    s_mov_b32 m0, 156672
    s_nop 0
    buffer_load_dwordx4 v11, s[52:55], s9 offen lds
    s_add_u32 s70, s38, 11272192
    s_addc_u32 s71, s39, 0
    s_load_dwordx2 s[68:69], s[70:71], 0
    s_mov_b32 s48, s38
    s_and_b32 s49, s39, 0xffff
    s_mov_b32 s50, 33554432
    s_mov_b32 s51, 0x00020000
    s_waitcnt vmcnt(12)
    s_waitcnt lgkmcnt(0)
    s_barrier
    s_add_u32 s60, s6, 2
    s_and_b32 s60, s60, 7
    s_lshl_b32 s60, s60, 7
    s_add_u32 m0, s13, 16384
    s_add_u32 s60, s60, s10
    buffer_load_dwordx4 v8, s[40:43], s60 offen offset:0 lds
    buffer_load_dwordx4 v9, s[40:43], s60 offen offset:1024 lds
    s_lshl_b32 s61, s6, 1
    s_add_u32 s61, s61, 4
    s_and_b32 s61, s61, 15
    s_mul_i32 s61, s61, 98304
    s_add_u32 m0, s14, 77824
    s_add_u32 s61, s61, s11
    buffer_load_dwordx4 v10, s[44:47], s61 offen offset:0 lds
    buffer_load_dwordx4 v10, s[44:47], s61 offen offset:1024 lds
    buffer_load_dwordx4 v10, s[44:47], s61 offen offset:2048 lds
    s_waitcnt vmcnt(14)
    s_barrier
    s_lshl_b32 s61, s6, 1
    s_add_u32 s61, s61, 5
    s_and_b32 s61, s61, 15
    s_mul_i32 s61, s61, 98304
    s_add_u32 m0, s14, 90112
    s_add_u32 s61, s61, s11
    buffer_load_dwordx4 v10, s[44:47], s61 offen offset:0 lds
    buffer_load_dwordx4 v10, s[44:47], s61 offen offset:1024 lds
    buffer_load_dwordx4 v10, s[44:47], s61 offen offset:2048 lds
    s_waitcnt vmcnt(12)
    s_barrier
    s_add_u32 s60, s6, 3
    s_and_b32 s60, s60, 7
    s_lshl_b32 s60, s60, 7
    s_add_u32 m0, s13, 24576
    s_add_u32 s60, s60, s10
    buffer_load_dwordx4 v8, s[40:43], s60 offen offset:0 lds
    buffer_load_dwordx4 v9, s[40:43], s60 offen offset:1024 lds
    s_lshl_b32 s61, s6, 1
    s_add_u32 s61, s61, 6
    s_and_b32 s61, s61, 15
    s_mul_i32 s61, s61, 98304
    s_add_u32 m0, s14, 102400
    s_add_u32 s61, s61, s11
    buffer_load_dwordx4 v10, s[44:47], s61 offen offset:0 lds
    buffer_load_dwordx4 v10, s[44:47], s61 offen offset:1024 lds
    buffer_load_dwordx4 v10, s[44:47], s61 offen offset:2048 lds
    s_waitcnt vmcnt(14)
    s_barrier
    s_lshl_b32 s61, s6, 1
    s_add_u32 s61, s61, 7
    s_and_b32 s61, s61, 15
    s_mul_i32 s61, s61, 98304
    s_add_u32 m0, s14, 114688
    s_add_u32 s61, s61, s11
    buffer_load_dwordx4 v10, s[44:47], s61 offen offset:0 lds
    buffer_load_dwordx4 v10, s[44:47], s61 offen offset:1024 lds
    buffer_load_dwordx4 v10, s[44:47], s61 offen offset:2048 lds
    s_waitcnt vmcnt(11)
    s_barrier
    s_add_u32 s60, s6, 4
    s_and_b32 s60, s60, 7
    s_lshl_b32 s60, s60, 7
    s_add_u32 m0, s13, 32768
    s_add_u32 s60, s60, s10
    buffer_load_dwordx4 v8, s[40:43], s60 offen offset:0 lds
    buffer_load_dwordx4 v9, s[40:43], s60 offen offset:1024 lds
    s_lshl_b32 s61, s6, 1
    s_add_u32 s61, s61, 8
    s_and_b32 s61, s61, 15
    s_mul_i32 s61, s61, 98304
    s_add_u32 m0, s14, 65536
    s_add_u32 s61, s61, s11
    buffer_load_dwordx4 v10, s[44:47], s61 offen offset:0 lds
    buffer_load_dwordx4 v10, s[44:47], s61 offen offset:1024 lds
    buffer_load_dwordx4 v10, s[44:47], s61 offen offset:2048 lds
    s_waitcnt vmcnt(13)
    s_barrier
    s_lshl_b32 s61, s6, 1
    s_add_u32 s61, s61, 9
    s_and_b32 s61, s61, 15
    s_mul_i32 s61, s61, 98304
    s_add_u32 m0, s14, 77824
    s_add_u32 s61, s61, s11
    buffer_load_dwordx4 v10, s[44:47], s61 offen offset:0 lds
    buffer_load_dwordx4 v10, s[44:47], s61 offen offset:1024 lds
    buffer_load_dwordx4 v10, s[44:47], s61 offen offset:2048 lds
    s_waitcnt vmcnt(11)
    s_barrier
    s_add_u32 s60, s6, 5
    s_and_b32 s60, s60, 7
    s_lshl_b32 s60, s60, 7
    s_add_u32 m0, s13, 40960
    s_add_u32 s60, s60, s10
    buffer_load_dwordx4 v8, s[40:43], s60 offen offset:0 lds
    buffer_load_dwordx4 v9, s[40:43], s60 offen offset:1024 lds
    s_lshl_b32 s61, s6, 1
    s_add_u32 s61, s61, 10
    s_and_b32 s61, s61, 15
    s_mul_i32 s61, s61, 98304
    s_add_u32 m0, s14, 90112
    s_add_u32 s61, s61, s11
    buffer_load_dwordx4 v10, s[44:47], s61 offen offset:0 lds
    buffer_load_dwordx4 v10, s[44:47], s61 offen offset:1024 lds
    buffer_load_dwordx4 v10, s[44:47], s61 offen offset:2048 lds
    s_waitcnt vmcnt(13)
    s_barrier
    s_lshl_b32 s61, s6, 1
    s_add_u32 s61, s61, 11
    s_and_b32 s61, s61, 15
    s_mul_i32 s61, s61, 98304
    s_add_u32 m0, s14, 102400
    s_add_u32 s61, s61, s11
    buffer_load_dwordx4 v10, s[44:47], s61 offen offset:0 lds
    buffer_load_dwordx4 v10, s[44:47], s61 offen offset:1024 lds
    buffer_load_dwordx4 v10, s[44:47], s61 offen offset:2048 lds
    s_waitcnt vmcnt(11)
    s_barrier
    s_add_u32 s60, s6, 6
    s_and_b32 s60, s60, 7
    s_lshl_b32 s60, s60, 7
    s_add_u32 m0, s13, 49152
    s_add_u32 s60, s60, s10
    buffer_load_dwordx4 v8, s[40:43], s60 offen offset:0 lds
    buffer_load_dwordx4 v9, s[40:43], s60 offen offset:1024 lds
    s_lshl_b32 s61, s6, 1
    s_add_u32 s61, s61, 12
    s_and_b32 s61, s61, 15
    s_mul_i32 s61, s61, 98304
    s_add_u32 m0, s14, 114688
    s_add_u32 s61, s61, s11
    buffer_load_dwordx4 v10, s[44:47], s61 offen offset:0 lds
    buffer_load_dwordx4 v10, s[44:47], s61 offen offset:1024 lds
    buffer_load_dwordx4 v10, s[44:47], s61 offen offset:2048 lds
    s_waitcnt vmcnt(13)
    s_barrier
    s_lshl_b32 s61, s6, 1
    s_add_u32 s61, s61, 13
    s_and_b32 s61, s61, 15
    s_mul_i32 s61, s61, 98304
    s_add_u32 m0, s14, 65536
    s_add_u32 s61, s61, s11
    buffer_load_dwordx4 v10, s[44:47], s61 offen offset:0 lds
    buffer_load_dwordx4 v10, s[44:47], s61 offen offset:1024 lds
    buffer_load_dwordx4 v10, s[44:47], s61 offen offset:2048 lds
    s_waitcnt vmcnt(11)
    s_barrier
    s_add_u32 s60, s6, 7
    s_and_b32 s60, s60, 7
    s_lshl_b32 s60, s60, 7
    s_add_u32 m0, s13, 57344
    s_add_u32 s60, s60, s10
    buffer_load_dwordx4 v8, s[40:43], s60 offen offset:0 lds
    buffer_load_dwordx4 v9, s[40:43], s60 offen offset:1024 lds
    s_lshl_b32 s61, s6, 1
    s_add_u32 s61, s61, 14
    s_and_b32 s61, s61, 15
    s_mul_i32 s61, s61, 98304
    s_add_u32 m0, s14, 77824
    s_add_u32 s61, s61, s11
    buffer_load_dwordx4 v10, s[44:47], s61 offen offset:0 lds
    buffer_load_dwordx4 v10, s[44:47], s61 offen offset:1024 lds
    buffer_load_dwordx4 v10, s[44:47], s61 offen offset:2048 lds
    s_waitcnt vmcnt(13)
    s_barrier
    s_lshl_b32 s61, s6, 1
    s_add_u32 s61, s61, 15
    s_and_b32 s61, s61, 15
    s_mul_i32 s61, s61, 98304
    s_add_u32 m0, s14, 90112
    s_add_u32 s61, s61, s11
    buffer_load_dwordx4 v10, s[44:47], s61 offen offset:0 lds
    buffer_load_dwordx4 v10, s[44:47], s61 offen offset:1024 lds
    buffer_load_dwordx4 v10, s[44:47], s61 offen offset:2048 lds
    s_waitcnt vmcnt(11)
    s_barrier
    s_waitcnt vmcnt(8)
    s_barrier
    s_waitcnt vmcnt(3)
    s_barrier
    s_waitcnt vmcnt(0)
    s_barrier
    s_mul_i32 s68, s68, 1664525
    s_add_u32 s68, s68, 1013904223
    s_mul_i32 s69, s69, 22695477
    s_add_u32 s69, s69, 12345
    s_lshl_b32 s11, s66, 3
    s_add_u32 s11, s11, s67
    s_lshl_b32 s11, s11, 9
    s_lshl_b32 s9, s7, 7
    s_add_u32 s11, s11, s9
    s_add_u32 s11, s11, 10485760
    s_add_u32 s70, s38, s11
    s_addc_u32 s71, s39, 0
    v_mov_b32 v5, 163800
    v_mov_b32 v6, 1
    s_mov_b32 s64, 0
L_pg:
    s_add_u32 s64, s64, 1
    s_cmp_ge_u32 s64, 65536
    s_cbranch_scc1 L_pg_ok
    s_sleep 2
    s_load_dwordx16 s[16:31], s[70:71], 0 glc
    s_load_dwordx16 s[32:47], s[70:71], 64 glc
    s_waitcnt lgkmcnt(0)
    s_cmp_lg_u64 s[16:17], s[68:69]
    s_cbranch_scc1 L_pg
    s_cmp_lg_u64 s[18:19], s[68:69]
    s_cbranch_scc1 L_pg
    s_cmp_lg_u64 s[20:21], s[68:69]
    s_cbranch_scc1 L_pg
    s_cmp_lg_u64 s[22:23], s[68:69]
    s_cbranch_scc1 L_pg
    s_cmp_lg_u64 s[24:25], s[68:69]
    s_cbranch_scc1 L_pg
    s_cmp_lg_u64 s[26:27], s[68:69]
    s_cbranch_scc1 L_pg
    s_cmp_lg_u64 s[28:29], s[68:69]
    s_cbranch_scc1 L_pg
    s_cmp_lg_u64 s[30:31], s[68:69]
    s_cbranch_scc1 L_pg
    s_cmp_lg_u64 s[32:33], s[68:69]
    s_cbranch_scc1 L_pg
    s_cmp_lg_u64 s[34:35], s[68:69]
    s_cbranch_scc1 L_pg
    s_cmp_lg_u64 s[36:37], s[68:69]
    s_cbranch_scc1 L_pg
    s_cmp_lg_u64 s[38:39], s[68:69]
    s_cbranch_scc1 L_pg
    s_cmp_lg_u64 s[40:41], s[68:69]
    s_cbranch_scc1 L_pg
    s_cmp_lg_u64 s[42:43], s[68:69]
    s_cbranch_scc1 L_pg
    s_cmp_lg_u64 s[44:45], s[68:69]
    s_cbranch_scc1 L_pg
    s_cmp_lg_u64 s[46:47], s[68:69]
    s_cbranch_scc1 L_pg
L_pg_ok:
    s_mov_b64 exec, 1
    ds_add_u32 v5, v6
    s_mov_b64 exec, -1
L_Cd:
    s_sub_u32 s7, s3, 4
    s_branch L_attn
L_B:
    s_getpc_b64 s[62:63]
L_pc:
    s_sub_u32 s62, s62, L_pc-gated_mix__softmax_full_mha__dense_activation_gelu__prompt_kernel
    s_subb_u32 s63, s63, 0
    s_lshr_b32 s9, s2, 3
    s_mul_i32 s9, s9, 10
    v_add_lshl_u32 v166, v1, s9, 7
    v_min_u32 v166, L_end-gated_mix__softmax_full_mha__dense_activation_gelu__prompt_kernel, v166
    s_cmp_lg_u32 s3, 4
    s_cbranch_scc1 L_pcs
    s_mov_b64 exec, 0x3ff
    global_load_dword v167, v166, s[62:63]
    s_mov_b64 exec, -1
L_pcs:
    s_and_b32 s12, s3, 3
    s_and_b32 s7, s3, 1
    s_bfe_u32 s8, s3, 0x10001
    s_bfe_u32 s59, s4, 0x10002
    s_lshl_b32 s10, s59, 13
    v_bfe_u32 v5, v3, 1, 3
    v_lshlrev_b32 v6, 7, v3
    v_add_u32 v6, s10, v6
    v_add_u32 v7, 0, v4
    v_xor_b32 v7, v7, v5
    v_lshl_add_u32 v8, v7, 4, v6
    v_add_u32 v7, 2, v4
    v_xor_b32 v7, v7, v5
    v_lshl_add_u32 v9, v7, 4, v6
    v_add_u32 v7, 4, v4
    v_xor_b32 v7, v7, v5
    v_lshl_add_u32 v10, v7, 4, v6
    v_add_u32 v7, 6, v4
    v_xor_b32 v7, v7, v5
    v_lshl_add_u32 v11, v7, 4, v6
    s_mul_i32 s63, s5, 7
    s_and_b32 s61, s5, 1
    s_add_u32 s63, s63, s61
    s_lshl_b32 s9, s12, 1
    s_add_u32 s63, s63, s9
    s_mul_i32 s61, s61, s12
    s_mul_i32 s13, s12, 6144
    s_add_u32 s62, s13, 106496
    s_add_u32 s13, s13, 131072
    v_bfe_u32 v5, v1, 2, 2
    v_lshlrev_b32 v6, 10, v4
    v_lshl_add_u32 v6, v5, 7, v6
    v_bfe_u32 v7, v1, 4, 1
    v_lshl_add_u32 v6, v7, 5, v6
    v_and_b32 v7, 3, v1
    v_lshl_add_u32 v6, v7, 3, v6
    v_add_u32 v6, s62, v6
    v_lshrrev_b32 v5, 1, v5
    v_lshl_add_u32 v12, v5, 6, v6
    v_xor_b32 v5, 1, v5
    v_lshl_add_u32 v13, v5, 6, v6
    v_lshrrev_b32 v5, 3, v1
    v_mul_u32_u24 v14, 3584, v5
    v_and_b32 v6, 7, v1
    v_bfe_u32 v7, v1, 4, 1
    v_lshlrev_b32 v7, 2, v7
    v_xor_b32 v7, v6, v7
    v_lshl_add_u32 v14, v7, 4, v14
    v_add_u32 v15, 27648, v14
    s_add_u32 s58, s6, s59
    s_lshl_b32 s15, s63, 6
    s_lshl_b32 s9, s12, 7
    s_add_u32 s9, s9, 156672
    v_lshl_add_u32 v5, v4, 3, s9
    s_waitcnt lgkmcnt(0)
    s_add_u32 s70, s38, 11272192
    s_addc_u32 s71, s39, 0
    s_load_dwordx2 s[68:69], s[70:71], 0
    s_mov_b32 s48, s38
    s_and_b32 s49, s39, 0xffff
    s_mov_b32 s50, 33554432
    s_mov_b32 s51, 0x00020000
    s_mov_b32 s52, s24
    s_and_b32 s53, s25, 0xffff
    s_mov_b32 s54, 1835008
    s_mov_b32 s55, 0x00020000
    s_waitcnt lgkmcnt(0)
    s_mul_i32 s68, s68, 1664525
    s_add_u32 s68, s68, 1013904223
    s_mul_i32 s69, s69, 22695477
    s_add_u32 s69, s69, 12345
    s_barrier
    s_barrier
    s_barrier
    s_barrier
    s_barrier
    s_barrier
    ds_read2_b64 v[80:83], v5 offset0:0 offset1:2
    ds_read2_b64 v[84:87], v5 offset0:4 offset1:6
    ds_read2_b64 v[88:91], v5 offset0:8 offset1:10
    ds_read2_b64 v[92:95], v5 offset0:12 offset1:14
    s_barrier
    s_waitcnt lgkmcnt(0)
    v_lshlrev_b32 v48, 16, v80
    v_and_b32 v49, 0xffff0000, v80
    v_lshlrev_b32 v50, 16, v81
    v_and_b32 v51, 0xffff0000, v81
    v_lshlrev_b32 v52, 16, v82
    v_and_b32 v53, 0xffff0000, v82
    v_lshlrev_b32 v54, 16, v83
    v_and_b32 v55, 0xffff0000, v83
    s_barrier
    v_lshlrev_b32 v56, 16, v84
    v_and_b32 v57, 0xffff0000, v84
    v_lshlrev_b32 v58, 16, v85
    v_and_b32 v59, 0xffff0000, v85
    v_lshlrev_b32 v60, 16, v86
    v_and_b32 v61, 0xffff0000, v86
    v_lshlrev_b32 v62, 16, v87
    v_and_b32 v63, 0xffff0000, v87
    s_barrier
    v_lshlrev_b32 v64, 16, v88
    v_and_b32 v65, 0xffff0000, v88
    v_lshlrev_b32 v66, 16, v89
    v_and_b32 v67, 0xffff0000, v89
    v_lshlrev_b32 v68, 16, v90
    v_and_b32 v69, 0xffff0000, v90
    v_lshlrev_b32 v70, 16, v91
    v_and_b32 v71, 0xffff0000, v91
    s_barrier
    v_lshlrev_b32 v72, 16, v92
    v_and_b32 v73, 0xffff0000, v92
    v_lshlrev_b32 v74, 16, v93
    v_and_b32 v75, 0xffff0000, v93
    v_lshlrev_b32 v76, 16, v94
    v_and_b32 v77, 0xffff0000, v94
    v_lshlrev_b32 v78, 16, v95
    v_and_b32 v79, 0xffff0000, v95
    s_barrier
    s_barrier
    s_barrier
    s_cmp_eq_u32 s61, 3
    s_cbranch_scc1 L_bi012
    s_add_u32 s14, s58, 0
    s_and_b32 s14, s14, 7
    s_mul_i32 s14, s14, 229376
    s_add_u32 s14, s14, s15
    s_add_u32 m0, s13, 0
    s_nop 0
    buffer_load_dwordx4 v14, s[52:55], s14 offen lds
    buffer_load_dwordx4 v15, s[52:55], s14 offen offset:1024 lds
    s_add_u32 s14, s14, 57344
    s_add_u32 m0, s13, 2048
    s_nop 0
    buffer_load_dwordx4 v14, s[52:55], s14 offen lds
    buffer_load_dwordx4 v15, s[52:55], s14 offen offset:1024 lds
    s_add_u32 s14, s14, 57344
    s_add_u32 m0, s13, 4096
    s_nop 0
    buffer_load_dwordx4 v14, s[52:55], s14 offen lds
    buffer_load_dwordx4 v15, s[52:55], s14 offen offset:1024 lds
    s_add_u32 s14, s14, 57344
L_bi012:
    s_barrier
    s_barrier
    s_barrier
    s_cmp_eq_u32 s61, 3
    s_cbranch_scc1 L_bi015
    s_add_u32 m0, s62, 0
    s_nop 0
    buffer_load_dwordx4 v14, s[52:55], s14 offen lds
    buffer_load_dwordx4 v15, s[52:55], s14 offen offset:1024 lds
    s_add_u32 s14, s14, 57344
    s_add_u32 s14, s58, 1
    s_and_b32 s14, s14, 7
    s_mul_i32 s14, s14, 229376
    s_add_u32 s14, s14, s15
    s_add_u32 m0, s62, 2048
    s_nop 0
    buffer_load_dwordx4 v14, s[52:55], s14 offen lds
    buffer_load_dwordx4 v15, s[52:55], s14 offen offset:1024 lds
    s_add_u32 s14, s14, 57344
    s_add_u32 m0, s62, 4096
    s_nop 0
    buffer_load_dwordx4 v14, s[52:55], s14 offen lds
    buffer_load_dwordx4 v15, s[52:55], s14 offen offset:1024 lds
    s_add_u32 s14, s14, 57344
L_bi015:
    s_branch L_B2
L_A:
    s_and_b32 s7, s3, 1
    s_lshr_b32 s8, s3, 1
    s_lshl_b32 s10, s7, 12
    v_bfe_u32 v5, v3, 1, 3
    v_lshlrev_b32 v6, 7, v3
    v_add_u32 v6, s10, v6
    s_lshl_b32 s9, s8, 1
    v_xor_b32 v5, s9, v5
    v_add_u32 v7, 0, v4
    v_xor_b32 v7, v7, v5
    v_lshl_add_u32 v8, v7, 4, v6
    v_add_u32 v7, 2, v4
    v_xor_b32 v7, v7, v5
    v_lshl_add_u32 v9, v7, 4, v6
    v_add_u32 v7, 4, v4
    v_xor_b32 v7, v7, v5
    v_lshl_add_u32 v10, v7, 4, v6
    v_add_u32 v7, 6, v4
    v_xor_b32 v7, v7, v5
    v_lshl_add_u32 v11, v7, 4, v6
    v_bfe_u32 v5, v1, 2, 2
    v_mul_u32_u24 v6, 3072, v4
    v_lshl_add_u32 v6, v5, 7, v6
    v_lshrrev_b32 v5, 1, v5
    v_xor_b32 v5, s8, v5
    v_lshl_add_u32 v6, v5, 6, v6
    v_bfe_u32 v5, v1, 4, 1
    v_lshl_add_u32 v6, v5, 5, v6
    v_and_b32 v5, 3, v1
    v_lshl_add_u32 v6, v5, 3, v6
    s_mul_i32 s9, s8, 6144
    s_sub_u32 s10, 6144, s9
    v_add_u32 v6, 65536, v6
    v_add_u32 v12, s9, v6
    v_add_u32 v13, s10, v6
    v_mov_b32 v6, 0
    v_mov_b32 v7, 163776
    v_lshl_add_u32 v7, v1, 2, v7
    s_mov_b64 exec, 0xffff
    ds_write_b32 v7, v6
    s_mov_b64 exec, -1
    s_waitcnt lgkmcnt(0)
    s_add_u32 s70, s38, 11272192
    s_addc_u32 s71, s39, 0
    s_load_dwordx2 s[68:69], s[70:71], 0
    s_mov_b32 s48, s38
    s_and_b32 s49, s39, 0xffff
    s_mov_b32 s50, 33554432
    s_mov_b32 s51, 0x00020000
    s_lshl_b32 s9, s4, 1
    s_add_u32 s9, s9, s7
    s_lshl_b32 s10, s5, 1
    s_add_u32 s10, s10, s8
    s_lshl_b32 s10, s10, 17
    s_lshl_b32 s9, s9, 10
    s_add_u32 s10, s10, s9
    v_lshlrev_b32 v153, 4, v1
    v_bfe_u32 v6, v1, 4, 1
    v_lshlrev_b32 v6, 16, v6
    v_lshl_add_u32 v6, v4, 8, v6
    v_and_b32 v7, 15, v1
    v_lshl_add_u32 v154, v7, 4, v6
    v_lshlrev_b32 v155, 9, v1
    s_lshl_b32 s11, s5, 5
    s_lshl_b32 s12, s8, 4
    s_add_u32 s12, s12, s11
    s_lshl_b32 s12, s12, 9
    s_lshr_b32 s9, s9, 7
    s_add_u32 s12, s12, s9
    s_add_u32 s12, s12, 10485760
    v_mov_b32 v157, 163800
    v_mov_b32 v156, 1
    s_setprio 1
    s_barrier
    ds_read_b128 v[16:19], v8 offset:0
    ds_read_b64_tr_b16 v[20:21], v12 offset:24576
    ds_read_b64_tr_b16 v[22:23], v12 offset:25088
    ds_read_b64_tr_b16 v[24:25], v12 offset:25600
    ds_read_b64_tr_b16 v[26:27], v12 offset:26112
    ds_read_b64_tr_b16 v[28:29], v12 offset:26624
    ds_read_b64_tr_b16 v[30:31], v12 offset:27136
    ds_read_b128 v[32:35], v9 offset:0
    ds_read_b64_tr_b16 v[36:37], v13 offset:24576
    ds_read_b64_tr_b16 v[38:39], v13 offset:25088
    ds_read_b64_tr_b16 v[40:41], v13 offset:25600
    ds_read_b64_tr_b16 v[42:43], v13 offset:26112
    ds_read_b64_tr_b16 v[44:45], v13 offset:26624
    ds_read_b64_tr_b16 v[46:47], v13 offset:27136
    s_waitcnt lgkmcnt(0)
    s_barrier
    v_mfma_f32_32x32x16_bf16 v[96:111], v[24:27], v[16:19], 0
    ds_read_b128 v[48:51], v10 offset:0
    ds_read_b64_tr_b16 v[52:53], v12 offset:36864
    ds_read_b64_tr_b16 v[54:55], v12 offset:37376
    v_mfma_f32_32x32x16_bf16 v[112:127], v[16:19], v[28:31], 0
    ds_read_b64_tr_b16 v[56:57], v12 offset:37888
    ds_read_b64_tr_b16 v[58:59], v12 offset:38400
    ds_read_b64_tr_b16 v[60:61], v12 offset:38912
    v_mfma_f32_32x32x16_bf16 v[80:95], v[20:23], v[16:19], 0
    ds_read_b64_tr_b16 v[62:63], v12 offset:39424
    ds_read_b128 v[64:67], v11 offset:0
    ds_read_b64_tr_b16 v[68:69], v13 offset:36864
    v_mfma_f32_32x32x16_bf16 v[96:111], v[40:43], v[32:35], v[96:111]
    ds_read_b64_tr_b16 v[70:71], v13 offset:37376
    ds_read_b64_tr_b16 v[72:73], v13 offset:37888
    ds_read_b64_tr_b16 v[74:75], v13 offset:38400
    v_mfma_f32_32x32x16_bf16 v[112:127], v[32:35], v[44:47], v[112:127]
    ds_read_b64_tr_b16 v[76:77], v13 offset:38912
    ds_read_b64_tr_b16 v[78:79], v13 offset:39424
    v_mfma_f32_32x32x16_bf16 v[80:95], v[36:39], v[32:35], v[80:95]
    s_waitcnt lgkmcnt(0)
    s_barrier
    v_mfma_f32_32x32x16_bf16 v[96:111], v[56:59], v[48:51], v[96:111]
    ds_read_b128 v[16:19], v8 offset:8192
    ds_read_b64_tr_b16 v[20:21], v12 offset:49152
    ds_read_b64_tr_b16 v[22:23], v12 offset:49664
    v_mfma_f32_32x32x16_bf16 v[112:127], v[48:51], v[60:63], v[112:127]
    ds_read_b64_tr_b16 v[24:25], v12 offset:50176
    ds_read_b64_tr_b16 v[26:27], v12 offset:50688
    ds_read_b64_tr_b16 v[28:29], v12 offset:51200
    v_mfma_f32_32x32x16_bf16 v[80:95], v[52:55], v[48:51], v[80:95]
    ds_read_b64_tr_b16 v[30:31], v12 offset:51712
    ds_read_b128 v[32:35], v9 offset:8192
    ds_read_b64_tr_b16 v[36:37], v13 offset:49152
    v_mfma_f32_32x32x16_bf16 v[96:111], v[72:75], v[64:67], v[96:111]
    ds_read_b64_tr_b16 v[38:39], v13 offset:49664
    ds_read_b64_tr_b16 v[40:41], v13 offset:50176
    ds_read_b64_tr_b16 v[42:43], v13 offset:50688
    v_mfma_f32_32x32x16_bf16 v[112:127], v[64:67], v[76:79], v[112:127]
    ds_read_b64_tr_b16 v[44:45], v13 offset:51200
    ds_read_b64_tr_b16 v[46:47], v13 offset:51712
    v_mfma_f32_32x32x16_bf16 v[80:95], v[68:71], v[64:67], v[80:95]
    s_waitcnt lgkmcnt(0)
    s_barrier
    v_mfma_f32_32x32x16_bf16 v[96:111], v[24:27], v[16:19], v[96:111]
    ds_read_b128 v[48:51], v10 offset:8192
    ds_read_b64_tr_b16 v[52:53], v12 offset:0
    ds_read_b64_tr_b16 v[54:55], v12 offset:512
    v_mfma_f32_32x32x16_bf16 v[112:127], v[16:19], v[28:31], v[112:127]
    ds_read_b64_tr_b16 v[56:57], v12 offset:1024
    ds_read_b64_tr_b16 v[58:59], v12 offset:1536
    ds_read_b64_tr_b16 v[60:61], v12 offset:2048
    v_mfma_f32_32x32x16_bf16 v[80:95], v[20:23], v[16:19], v[80:95]
    ds_read_b64_tr_b16 v[62:63], v12 offset:2560
    ds_read_b128 v[64:67], v11 offset:8192
    ds_read_b64_tr_b16 v[68:69], v13 offset:0
    v_mfma_f32_32x32x16_bf16 v[96:111], v[40:43], v[32:35], v[96:111]
    ds_read_b64_tr_b16 v[70:71], v13 offset:512
    ds_read_b64_tr_b16 v[72:73], v13 offset:1024
    ds_read_b64_tr_b16 v[74:75], v13 offset:1536
    v_mfma_f32_32x32x16_bf16 v[112:127], v[32:35], v[44:47], v[112:127]
    ds_read_b64_tr_b16 v[76:77], v13 offset:2048
    ds_read_b64_tr_b16 v[78:79], v13 offset:2560
    v_mfma_f32_32x32x16_bf16 v[80:95], v[36:39], v[32:35], v[80:95]
    s_waitcnt lgkmcnt(0)
    s_barrier
    v_mfma_f32_32x32x16_bf16 v[96:111], v[56:59], v[48:51], v[96:111]
    ds_read_b128 v[16:19], v8 offset:16384
    ds_read_b64_tr_b16 v[20:21], v12 offset:12288
    ds_read_b64_tr_b16 v[22:23], v12 offset:12800
    v_mfma_f32_32x32x16_bf16 v[112:127], v[48:51], v[60:63], v[112:127]
    ds_read_b64_tr_b16 v[24:25], v12 offset:13312
    ds_read_b64_tr_b16 v[26:27], v12 offset:13824
    ds_read_b64_tr_b16 v[28:29], v12 offset:14336
    v_mfma_f32_32x32x16_bf16 v[80:95], v[52:55], v[48:51], v[80:95]
    ds_read_b64_tr_b16 v[30:31], v12 offset:14848
    ds_read_b128 v[32:35], v9 offset:16384
    ds_read_b64_tr_b16 v[36:37], v13 offset:12288
    v_mfma_f32_32x32x16_bf16 v[96:111], v[72:75], v[64:67], v[96:111]
    ds_read_b64_tr_b16 v[38:39], v13 offset:12800
    ds_read_b64_tr_b16 v[40:41], v13 offset:13312
    ds_read_b64_tr_b16 v[42:43], v13 offset:13824
    v_mfma_f32_32x32x16_bf16 v[112:127], v[64:67], v[76:79], v[112:127]
    ds_read_b64_tr_b16 v[44:45], v13 offset:14336
    ds_read_b64_tr_b16 v[46:47], v13 offset:14848
    v_mfma_f32_32x32x16_bf16 v[80:95], v[68:71], v[64:67], v[80:95]
    s_waitcnt lgkmcnt(0)
    s_barrier
    v_mfma_f32_32x32x16_bf16 v[96:111], v[24:27], v[16:19], v[96:111]
    ds_read_b128 v[48:51], v10 offset:16384
    ds_read_b64_tr_b16 v[52:53], v12 offset:24576
    ds_read_b64_tr_b16 v[54:55], v12 offset:25088
    v_mfma_f32_32x32x16_bf16 v[112:127], v[16:19], v[28:31], v[112:127]
    ds_read_b64_tr_b16 v[56:57], v12 offset:25600
    ds_read_b64_tr_b16 v[58:59], v12 offset:26112
    ds_read_b64_tr_b16 v[60:61], v12 offset:26624
    v_mfma_f32_32x32x16_bf16 v[80:95], v[20:23], v[16:19], v[80:95]
    ds_read_b64_tr_b16 v[62:63], v12 offset:27136
    ds_read_b128 v[64:67], v11 offset:16384
    ds_read_b64_tr_b16 v[68:69], v13 offset:24576
    v_mfma_f32_32x32x16_bf16 v[96:111], v[40:43], v[32:35], v[96:111]
    ds_read_b64_tr_b16 v[70:71], v13 offset:25088
    ds_read_b64_tr_b16 v[72:73], v13 offset:25600
    ds_read_b64_tr_b16 v[74:75], v13 offset:26112
    v_mfma_f32_32x32x16_bf16 v[112:127], v[32:35], v[44:47], v[112:127]
    ds_read_b64_tr_b16 v[76:77], v13 offset:26624
    ds_read_b64_tr_b16 v[78:79], v13 offset:27136
    v_mfma_f32_32x32x16_bf16 v[80:95], v[36:39], v[32:35], v[80:95]
    s_waitcnt lgkmcnt(0)
    s_barrier
    v_mfma_f32_32x32x16_bf16 v[96:111], v[56:59], v[48:51], v[96:111]
    ds_read_b128 v[16:19], v8 offset:24576
    ds_read_b64_tr_b16 v[20:21], v12 offset:36864
    ds_read_b64_tr_b16 v[22:23], v12 offset:37376
    v_mfma_f32_32x32x16_bf16 v[112:127], v[48:51], v[60:63], v[112:127]
    ds_read_b64_tr_b16 v[24:25], v12 offset:37888
    ds_read_b64_tr_b16 v[26:27], v12 offset:38400
    ds_read_b64_tr_b16 v[28:29], v12 offset:38912
    v_mfma_f32_32x32x16_bf16 v[80:95], v[52:55], v[48:51], v[80:95]
    ds_read_b64_tr_b16 v[30:31], v12 offset:39424
    ds_read_b128 v[32:35], v9 offset:24576
    ds_read_b64_tr_b16 v[36:37], v13 offset:36864
    v_mfma_f32_32x32x16_bf16 v[96:111], v[72:75], v[64:67], v[96:111]
    ds_read_b64_tr_b16 v[38:39], v13 offset:37376
    ds_read_b64_tr_b16 v[40:41], v13 offset:37888
    ds_read_b64_tr_b16 v[42:43], v13 offset:38400
    v_mfma_f32_32x32x16_bf16 v[112:127], v[64:67], v[76:79], v[112:127]
    ds_read_b64_tr_b16 v[44:45], v13 offset:38912
    ds_read_b64_tr_b16 v[46:47], v13 offset:39424
    v_mfma_f32_32x32x16_bf16 v[80:95], v[68:71], v[64:67], v[80:95]
    s_waitcnt lgkmcnt(0)
    s_barrier
    v_mfma_f32_32x32x16_bf16 v[96:111], v[24:27], v[16:19], v[96:111]
    ds_read_b128 v[48:51], v10 offset:24576
    ds_read_b64_tr_b16 v[52:53], v12 offset:49152
    ds_read_b64_tr_b16 v[54:55], v12 offset:49664
    v_mfma_f32_32x32x16_bf16 v[112:127], v[16:19], v[28:31], v[112:127]
    ds_read_b64_tr_b16 v[56:57], v12 offset:50176
    ds_read_b64_tr_b16 v[58:59], v12 offset:50688
    ds_read_b64_tr_b16 v[60:61], v12 offset:51200
    v_mfma_f32_32x32x16_bf16 v[80:95], v[20:23], v[16:19], v[80:95]
    ds_read_b64_tr_b16 v[62:63], v12 offset:51712
    ds_read_b128 v[64:67], v11 offset:24576
    ds_read_b64_tr_b16 v[68:69], v13 offset:49152
    v_mfma_f32_32x32x16_bf16 v[96:111], v[40:43], v[32:35], v[96:111]
    ds_read_b64_tr_b16 v[70:71], v13 offset:49664
    ds_read_b64_tr_b16 v[72:73], v13 offset:50176
    ds_read_b64_tr_b16 v[74:75], v13 offset:50688
    v_mfma_f32_32x32x16_bf16 v[112:127], v[32:35], v[44:47], v[112:127]
    ds_read_b64_tr_b16 v[76:77], v13 offset:51200
    ds_read_b64_tr_b16 v[78:79], v13 offset:51712
    v_mfma_f32_32x32x16_bf16 v[80:95], v[36:39], v[32:35], v[80:95]
    s_waitcnt lgkmcnt(0)
    s_barrier
    v_mfma_f32_32x32x16_bf16 v[96:111], v[56:59], v[48:51], v[96:111]
    ds_read_b128 v[16:19], v8 offset:32768
    ds_read_b64_tr_b16 v[20:21], v12 offset:0
    ds_read_b64_tr_b16 v[22:23], v12 offset:512
    v_mfma_f32_32x32x16_bf16 v[112:127], v[48:51], v[60:63], v[112:127]
    ds_read_b64_tr_b16 v[24:25], v12 offset:1024
    ds_read_b64_tr_b16 v[26:27], v12 offset:1536
    ds_read_b64_tr_b16 v[28:29], v12 offset:2048
    v_mfma_f32_32x32x16_bf16 v[80:95], v[52:55], v[48:51], v[80:95]
    ds_read_b64_tr_b16 v[30:31], v12 offset:2560
    ds_read_b128 v[32:35], v9 offset:32768
    ds_read_b64_tr_b16 v[36:37], v13 offset:0
    v_mfma_f32_32x32x16_bf16 v[96:111], v[72:75], v[64:67], v[96:111]
    ds_read_b64_tr_b16 v[38:39], v13 offset:512
    ds_read_b64_tr_b16 v[40:41], v13 offset:1024
    ds_read_b64_tr_b16 v[42:43], v13 offset:1536
    v_mfma_f32_32x32x16_bf16 v[112:127], v[64:67], v[76:79], v[112:127]
    ds_read_b64_tr_b16 v[44:45], v13 offset:2048
    ds_read_b64_tr_b16 v[46:47], v13 offset:2560
    v_mfma_f32_32x32x16_bf16 v[80:95], v[68:71], v[64:67], v[80:95]
    s_waitcnt lgkmcnt(0)
    s_barrier
    v_mfma_f32_32x32x16_bf16 v[96:111], v[24:27], v[16:19], v[96:111]
    ds_read_b128 v[48:51], v10 offset:32768
    ds_read_b64_tr_b16 v[52:53], v12 offset:12288
    ds_read_b64_tr_b16 v[54:55], v12 offset:12800
    v_mfma_f32_32x32x16_bf16 v[112:127], v[16:19], v[28:31], v[112:127]
    ds_read_b64_tr_b16 v[56:57], v12 offset:13312
    ds_read_b64_tr_b16 v[58:59], v12 offset:13824
    ds_read_b64_tr_b16 v[60:61], v12 offset:14336
    v_mfma_f32_32x32x16_bf16 v[80:95], v[20:23], v[16:19], v[80:95]
    ds_read_b64_tr_b16 v[62:63], v12 offset:14848
    ds_read_b128 v[64:67], v11 offset:32768
    ds_read_b64_tr_b16 v[68:69], v13 offset:12288
    v_mfma_f32_32x32x16_bf16 v[96:111], v[40:43], v[32:35], v[96:111]
    ds_read_b64_tr_b16 v[70:71], v13 offset:12800
    ds_read_b64_tr_b16 v[72:73], v13 offset:13312
    ds_read_b64_tr_b16 v[74:75], v13 offset:13824
    v_mfma_f32_32x32x16_bf16 v[112:127], v[32:35], v[44:47], v[112:127]
    ds_read_b64_tr_b16 v[76:77], v13 offset:14336
    ds_read_b64_tr_b16 v[78:79], v13 offset:14848
    v_mfma_f32_32x32x16_bf16 v[80:95], v[36:39], v[32:35], v[80:95]
    s_waitcnt lgkmcnt(0)
    s_barrier
    v_mfma_f32_32x32x16_bf16 v[96:111], v[56:59], v[48:51], v[96:111]
    ds_read_b128 v[16:19], v8 offset:40960
    ds_read_b64_tr_b16 v[20:21], v12 offset:24576
    ds_read_b64_tr_b16 v[22:23], v12 offset:25088
    v_mfma_f32_32x32x16_bf16 v[112:127], v[48:51], v[60:63], v[112:127]
    ds_read_b64_tr_b16 v[24:25], v12 offset:25600
    ds_read_b64_tr_b16 v[26:27], v12 offset:26112
    ds_read_b64_tr_b16 v[28:29], v12 offset:26624
    v_mfma_f32_32x32x16_bf16 v[80:95], v[52:55], v[48:51], v[80:95]
    ds_read_b64_tr_b16 v[30:31], v12 offset:27136
    ds_read_b128 v[32:35], v9 offset:40960
    ds_read_b64_tr_b16 v[36:37], v13 offset:24576
    v_mfma_f32_32x32x16_bf16 v[96:111], v[72:75], v[64:67], v[96:111]
    ds_read_b64_tr_b16 v[38:39], v13 offset:25088
    ds_read_b64_tr_b16 v[40:41], v13 offset:25600
    ds_read_b64_tr_b16 v[42:43], v13 offset:26112
    v_mfma_f32_32x32x16_bf16 v[112:127], v[64:67], v[76:79], v[112:127]
    ds_read_b64_tr_b16 v[44:45], v13 offset:26624
    ds_read_b64_tr_b16 v[46:47], v13 offset:27136
    v_mfma_f32_32x32x16_bf16 v[80:95], v[68:71], v[64:67], v[80:95]
    s_waitcnt lgkmcnt(0)
    s_barrier
    v_mfma_f32_32x32x16_bf16 v[96:111], v[24:27], v[16:19], v[96:111]
    ds_read_b128 v[48:51], v10 offset:40960
    ds_read_b64_tr_b16 v[52:53], v12 offset:36864
    ds_read_b64_tr_b16 v[54:55], v12 offset:37376
    v_mfma_f32_32x32x16_bf16 v[112:127], v[16:19], v[28:31], v[112:127]
    ds_read_b64_tr_b16 v[56:57], v12 offset:37888
    ds_read_b64_tr_b16 v[58:59], v12 offset:38400
    ds_read_b64_tr_b16 v[60:61], v12 offset:38912
    v_mfma_f32_32x32x16_bf16 v[80:95], v[20:23], v[16:19], v[80:95]
    ds_read_b64_tr_b16 v[62:63], v12 offset:39424
    ds_read_b128 v[64:67], v11 offset:40960
    ds_read_b64_tr_b16 v[68:69], v13 offset:36864
    v_mfma_f32_32x32x16_bf16 v[96:111], v[40:43], v[32:35], v[96:111]
    ds_read_b64_tr_b16 v[70:71], v13 offset:37376
    ds_read_b64_tr_b16 v[72:73], v13 offset:37888
    ds_read_b64_tr_b16 v[74:75], v13 offset:38400
    v_mfma_f32_32x32x16_bf16 v[112:127], v[32:35], v[44:47], v[112:127]
    ds_read_b64_tr_b16 v[76:77], v13 offset:38912
    ds_read_b64_tr_b16 v[78:79], v13 offset:39424
    v_mfma_f32_32x32x16_bf16 v[80:95], v[36:39], v[32:35], v[80:95]
    s_waitcnt lgkmcnt(0)
    s_barrier
    v_mfma_f32_32x32x16_bf16 v[96:111], v[56:59], v[48:51], v[96:111]
    ds_read_b128 v[16:19], v8 offset:49152
    ds_read_b64_tr_b16 v[20:21], v12 offset:49152
    ds_read_b64_tr_b16 v[22:23], v12 offset:49664
    v_mfma_f32_32x32x16_bf16 v[112:127], v[48:51], v[60:63], v[112:127]
    ds_read_b64_tr_b16 v[24:25], v12 offset:50176
    ds_read_b64_tr_b16 v[26:27], v12 offset:50688
    ds_read_b64_tr_b16 v[28:29], v12 offset:51200
    v_mfma_f32_32x32x16_bf16 v[80:95], v[52:55], v[48:51], v[80:95]
    ds_read_b64_tr_b16 v[30:31], v12 offset:51712
    ds_read_b128 v[32:35], v9 offset:49152
    ds_read_b64_tr_b16 v[36:37], v13 offset:49152
    v_mfma_f32_32x32x16_bf16 v[96:111], v[72:75], v[64:67], v[96:111]
    ds_read_b64_tr_b16 v[38:39], v13 offset:49664
    ds_read_b64_tr_b16 v[40:41], v13 offset:50176
    ds_read_b64_tr_b16 v[42:43], v13 offset:50688
    v_mfma_f32_32x32x16_bf16 v[112:127], v[64:67], v[76:79], v[112:127]
    ds_read_b64_tr_b16 v[44:45], v13 offset:51200
    ds_read_b64_tr_b16 v[46:47], v13 offset:51712
    v_mfma_f32_32x32x16_bf16 v[80:95], v[68:71], v[64:67], v[80:95]
    s_waitcnt lgkmcnt(0)
    s_barrier
    v_mfma_f32_32x32x16_bf16 v[96:111], v[24:27], v[16:19], v[96:111]
    ds_read_b128 v[48:51], v10 offset:49152
    ds_read_b64_tr_b16 v[52:53], v12 offset:0
    ds_read_b64_tr_b16 v[54:55], v12 offset:512
    v_mfma_f32_32x32x16_bf16 v[112:127], v[16:19], v[28:31], v[112:127]
    ds_read_b64_tr_b16 v[56:57], v12 offset:1024
    ds_read_b64_tr_b16 v[58:59], v12 offset:1536
    ds_read_b64_tr_b16 v[60:61], v12 offset:2048
    v_mfma_f32_32x32x16_bf16 v[80:95], v[20:23], v[16:19], v[80:95]
    ds_read_b64_tr_b16 v[62:63], v12 offset:2560
    ds_read_b128 v[64:67], v11 offset:49152
    ds_read_b64_tr_b16 v[68:69], v13 offset:0
    v_mfma_f32_32x32x16_bf16 v[96:111], v[40:43], v[32:35], v[96:111]
    ds_read_b64_tr_b16 v[70:71], v13 offset:512
    ds_read_b64_tr_b16 v[72:73], v13 offset:1024
    ds_read_b64_tr_b16 v[74:75], v13 offset:1536
    v_mfma_f32_32x32x16_bf16 v[112:127], v[32:35], v[44:47], v[112:127]
    ds_read_b64_tr_b16 v[76:77], v13 offset:2048
    ds_read_b64_tr_b16 v[78:79], v13 offset:2560
    v_mfma_f32_32x32x16_bf16 v[80:95], v[36:39], v[32:35], v[80:95]
    s_waitcnt lgkmcnt(0)
    s_barrier
    v_mfma_f32_32x32x16_bf16 v[96:111], v[56:59], v[48:51], v[96:111]
    ds_read_b128 v[16:19], v8 offset:57344
    ds_read_b64_tr_b16 v[20:21], v12 offset:12288
    ds_read_b64_tr_b16 v[22:23], v12 offset:12800
    v_mfma_f32_32x32x16_bf16 v[112:127], v[48:51], v[60:63], v[112:127]
    ds_read_b64_tr_b16 v[24:25], v12 offset:13312
    ds_read_b64_tr_b16 v[26:27], v12 offset:13824
    ds_read_b64_tr_b16 v[28:29], v12 offset:14336
    v_mfma_f32_32x32x16_bf16 v[80:95], v[52:55], v[48:51], v[80:95]
    ds_read_b64_tr_b16 v[30:31], v12 offset:14848
    ds_read_b128 v[32:35], v9 offset:57344
    ds_read_b64_tr_b16 v[36:37], v13 offset:12288
    v_mfma_f32_32x32x16_bf16 v[96:111], v[72:75], v[64:67], v[96:111]
    ds_read_b64_tr_b16 v[38:39], v13 offset:12800
    ds_read_b64_tr_b16 v[40:41], v13 offset:13312
    ds_read_b64_tr_b16 v[42:43], v13 offset:13824
    v_mfma_f32_32x32x16_bf16 v[112:127], v[64:67], v[76:79], v[112:127]
    ds_read_b64_tr_b16 v[44:45], v13 offset:14336
    ds_read_b64_tr_b16 v[46:47], v13 offset:14848
    v_mfma_f32_32x32x16_bf16 v[80:95], v[68:71], v[64:67], v[80:95]
    s_waitcnt lgkmcnt(0)
    s_barrier
    v_mfma_f32_32x32x16_bf16 v[96:111], v[24:27], v[16:19], v[96:111]
    ds_read_b128 v[48:51], v10 offset:57344
    ds_read_b64_tr_b16 v[52:53], v12 offset:24576
    ds_read_b64_tr_b16 v[54:55], v12 offset:25088
    v_mfma_f32_32x32x16_bf16 v[112:127], v[16:19], v[28:31], v[112:127]
    ds_read_b64_tr_b16 v[56:57], v12 offset:25600
    ds_read_b64_tr_b16 v[58:59], v12 offset:26112
    ds_read_b64_tr_b16 v[60:61], v12 offset:26624
    v_mfma_f32_32x32x16_bf16 v[80:95], v[20:23], v[16:19], v[80:95]
    ds_read_b64_tr_b16 v[62:63], v12 offset:27136
    ds_read_b128 v[64:67], v11 offset:57344
    ds_read_b64_tr_b16 v[68:69], v13 offset:24576
    v_mfma_f32_32x32x16_bf16 v[96:111], v[40:43], v[32:35], v[96:111]
    ds_read_b64_tr_b16 v[70:71], v13 offset:25088
    ds_read_b64_tr_b16 v[72:73], v13 offset:25600
    ds_read_b64_tr_b16 v[74:75], v13 offset:26112
    v_mfma_f32_32x32x16_bf16 v[112:127], v[32:35], v[44:47], v[112:127]
    ds_read_b64_tr_b16 v[76:77], v13 offset:26624
    ds_read_b64_tr_b16 v[78:79], v13 offset:27136
    v_mfma_f32_32x32x16_bf16 v[80:95], v[36:39], v[32:35], v[80:95]
    s_waitcnt lgkmcnt(0)
    s_mov_b64 exec, 1
    ds_add_u32 v157, v156
    s_mov_b64 exec, -1
    v_mfma_f32_32x32x16_bf16 v[96:111], v[56:59], v[48:51], v[96:111]
    v_mfma_f32_32x32x16_bf16 v[112:127], v[48:51], v[60:63], v[112:127]
    v_mfma_f32_32x32x16_bf16 v[80:95], v[52:55], v[48:51], v[80:95]
    v_mfma_f32_32x32x16_bf16 v[96:111], v[72:75], v[64:67], v[96:111]
    v_mfma_f32_32x32x16_bf16 v[112:127], v[64:67], v[76:79], v[112:127]
    v_mfma_f32_32x32x16_bf16 v[80:95], v[68:71], v[64:67], v[80:95]
    s_mul_i32 s68, s68, 1664525
    s_add_u32 s68, s68, 1013904223
    s_mul_i32 s69, s69, 22695477
    s_add_u32 s69, s69, 12345
    v_mov_b32 v158, s68
    v_mov_b32 v159, s69
    s_nop 3
    v_cvt_pk_bf16_f32 v24, v96, v97
    v_cvt_pk_bf16_f32 v25, v98, v99
    v_cvt_pk_bf16_f32 v26, v100, v101
    v_cvt_pk_bf16_f32 v27, v102, v103
    v_cvt_pk_bf16_f32 v28, v104, v105
    v_cvt_pk_bf16_f32 v29, v106, v107
    v_cvt_pk_bf16_f32 v30, v108, v109
    v_cvt_pk_bf16_f32 v31, v110, v111
    s_add_u32 s13, s10, 2097152
    buffer_store_dwordx4 v[24:27], v153, s[48:51], s13 offen sc1
    s_add_u32 s13, s10, 2162688
    buffer_store_dwordx4 v[28:31], v153, s[48:51], s13 offen sc1
    v_cvt_pk_bf16_f32 v32, v112, v113
    v_cvt_pk_bf16_f32 v33, v114, v115
    v_cvt_pk_bf16_f32 v34, v116, v117
    v_cvt_pk_bf16_f32 v35, v118, v119
    v_cvt_pk_bf16_f32 v36, v120, v121
    v_cvt_pk_bf16_f32 v37, v122, v123
    v_cvt_pk_bf16_f32 v38, v124, v125
    v_cvt_pk_bf16_f32 v39, v126, v127
    s_add_u32 s13, s10, 4194304
    buffer_store_dwordx4 v[32:35], v154, s[48:51], s13 offen sc1
    buffer_store_dwordx4 v[36:39], v154, s[48:51], s13 offen offset:512 sc1
    v_mul_f32 v80, 0x3eb8aa3b, v80
    v_mul_f32 v81, 0x3eb8aa3b, v81
    v_mul_f32 v82, 0x3eb8aa3b, v82
    v_mul_f32 v83, 0x3eb8aa3b, v83
    v_mul_f32 v84, 0x3eb8aa3b, v84
    v_mul_f32 v85, 0x3eb8aa3b, v85
    v_mul_f32 v86, 0x3eb8aa3b, v86
    v_mul_f32 v87, 0x3eb8aa3b, v87
    v_mul_f32 v88, 0x3eb8aa3b, v88
    v_mul_f32 v89, 0x3eb8aa3b, v89
    v_mul_f32 v90, 0x3eb8aa3b, v90
    v_mul_f32 v91, 0x3eb8aa3b, v91
    v_mul_f32 v92, 0x3eb8aa3b, v92
    v_mul_f32 v93, 0x3eb8aa3b, v93
    v_mul_f32 v94, 0x3eb8aa3b, v94
    v_mul_f32 v95, 0x3eb8aa3b, v95
    v_cvt_pk_bf16_f32 v16, v80, v81
    v_cvt_pk_bf16_f32 v17, v82, v83
    v_cvt_pk_bf16_f32 v18, v84, v85
    v_cvt_pk_bf16_f32 v19, v86, v87
    v_cvt_pk_bf16_f32 v20, v88, v89
    v_cvt_pk_bf16_f32 v21, v90, v91
    v_cvt_pk_bf16_f32 v22, v92, v93
    v_cvt_pk_bf16_f32 v23, v94, v95
    s_add_u32 s13, s10, 0
    buffer_store_dwordx4 v[16:19], v153, s[48:51], s13 offen sc1
    s_add_u32 s13, s10, 65536
    buffer_store_dwordx4 v[20:23], v153, s[48:51], s13 offen sc1
    s_waitcnt vmcnt(0)
    s_mov_b64 exec, 0xffff
    buffer_store_dwordx2 v[158:159], v155, s[48:51], s12 offen sc1
    s_mov_b64 exec, -1
    s_mov_b32 s7, s3
L_attn:
    v_lshlrev_b32 v104, 4, v1
    s_lshl_b32 s14, s67, 3
    s_add_u32 s14, s14, s7
    v_and_b32 v109, 15, v1
    v_lshlrev_b32 v109, 4, v109
    v_lshrrev_b32 v114, 5, v1
    v_lshl_add_u32 v106, v114, 8, v109
    v_add_u32 v110, 65536, v104
    v_add_u32 v111, 65536, v106
    v_and_b32 v109, 27, v1
    v_cmp_eq_u32 vcc, 16, v109
    v_mov_b32 v109, 0x3f803f80
    s_nop 0
    v_cndmask_b32 v109, 0, v109, vcc
    v_mov_b32 v16, v109
    v_mov_b32 v17, v109
    v_mov_b32 v18, v109
    v_mov_b32 v19, v109
    v_mov_b32 v20, v109
    v_mov_b32 v21, v109
    v_mov_b32 v22, v109
    v_mov_b32 v23, v109
    v_mov_b32 v24, v109
    v_mov_b32 v25, v109
    v_mov_b32 v26, v109
    v_mov_b32 v27, v109
    v_mov_b32 v28, v109
    v_mov_b32 v29, v109
    v_mov_b32 v30, v109
    v_mov_b32 v31, v109
    v_mov_b32 v88, 0
    v_mov_b32 v89, 0
    v_mov_b32 v90, 0
    v_mov_b32 v91, 0
    v_mov_b32 v92, 0
    v_mov_b32 v93, 0
    v_mov_b32 v94, 0
    v_mov_b32 v95, 0
    v_mov_b32 v96, 0
    v_mov_b32 v97, 0
    v_mov_b32 v98, 0
    v_mov_b32 v99, 0
    v_mov_b32 v100, 0
    v_mov_b32 v101, 0
    v_mov_b32 v102, 0
    v_mov_b32 v103, 0
    v_mov_b32 v84, 0
    v_mov_b32 v85, 0
    v_mov_b32 v86, 0
    v_mov_b32 v87, 0
    v_mov_b32 v112, 163776
    v_mov_b32 v113, 1
    v_mov_b32 v116, s68
    v_mov_b32 v117, s69
    v_lshlrev_b32 v118, 9, v1
    s_mov_b32 s20, 0x0000ffff
    s_mov_b32 s21, 0x0000ffff
    s_setprio 1
    s_and_b32 s9, s7, 1
    s_lshr_b32 s10, s7, 1
    s_lshl_b32 s10, s10, 10
    s_lshl_b32 s11, s9, 12
    s_add_u32 s11, s11, s10
    s_lshl_b32 s13, s66, 16
    s_lshl_b32 s12, s9, 21
    s_add_u32 s12, s12, s10
    s_add_u32 s12, s12, s13
    s_add_u32 s12, s12, 2097152
    s_lshl_b32 s15, s14, 10
    s_add_u32 s15, s15, s13
    s_lshl_b32 s22, s14, 15
    s_lshl_b32 s9, s66, 10
    s_add_u32 s22, s22, s9
    s_add_u32 s22, s22, 8388608
    v_mov_b32 v120, -1
    v_mov_b32 v121, -1
    v_mov_b32 v122, -1
    v_mov_b32 v123, -1
    s_mov_b32 s64, 0
    s_branch L_go_1
L_go:
    s_sleep 3
L_go_1:
    ds_read_b32 v114, v112 offset:24
    s_add_u32 s64, s64, 1
    s_waitcnt lgkmcnt(0)
    v_readfirstlane_b32 s25, v114
    s_lshr_b32 s65, s64, 18
    s_add_u32 s25, s25, s65
    s_cmp_lt_u32 s25, 8
    s_cbranch_scc1 L_go
    s_add_u32 m0, s11, 65536
    s_nop 0
    buffer_load_dwordx4 v104, s[48:51], s12 offen sc1 lds
    s_add_u32 s12, s12, 4096
    buffer_load_dwordx4 v[4:7], v104, s[48:51], s15 offen sc1
    s_add_u32 m0, s11, 73728
    s_nop 0
    buffer_load_dwordx4 v104, s[48:51], s12 offen sc1 lds
    s_add_u32 s12, s12, 4096
    s_add_u32 m0, s11, 81920
    s_nop 0
    buffer_load_dwordx4 v104, s[48:51], s12 offen sc1 lds
    s_add_u32 s12, s12, 4096
    s_add_u32 m0, s11, 90112
    s_nop 0
    buffer_load_dwordx4 v104, s[48:51], s12 offen sc1 lds
    s_add_u32 s12, s12, 4096
    s_add_u32 m0, s11, 98304
    s_nop 0
    buffer_load_dwordx4 v104, s[48:51], s12 offen sc1 lds
    s_add_u32 s12, s12, 4096
    s_lshr_b32 s10, s14, 1
    s_lshl_b32 s10, s10, 12
    s_and_b32 s11, s14, 1
    s_lshl_b32 s11, s11, 8
    s_add_u32 s10, s10, s11
    s_lshl_b32 s11, s66, 3
    s_add_u32 s10, s10, s11
    s_add_u32 s10, s10, 11010048
    s_waitcnt vmcnt(3)
    s_mov_b64 exec, 1
    ds_add_u32 v112, v113 offset:0
    s_mov_b64 exec, -1
    s_mov_b32 s64, 0
    s_branch L_s0_1
L_s0:
L_s0_1:
    ds_read_b32 v114, v112 offset:0
    s_add_u32 s64, s64, 1
    s_waitcnt lgkmcnt(0)
    v_readfirstlane_b32 s25, v114
    s_lshr_b32 s65, s64, 18
    s_add_u32 s25, s25, s65
    s_cmp_lt_u32 s25, 8
    s_cbranch_scc1 L_s0
    ds_read_b128 v[8:11], v110
    ds_read_b128 v[12:15], v110 offset:1024
    s_mov_b64 exec, s[20:21]
    ds_read_b128 v[16:19], v111 offset:4096
    ds_read_b128 v[20:23], v111 offset:4608
    s_mov_b64 exec, -1
    s_waitcnt lgkmcnt(3)
    v_mfma_f32_32x32x16_bf16 v[48:63], v[8:11], v[4:7], 0
    s_mov_b32 s27, 16786
    s_mov_b32 s26, 0
    s_nop 9
    v_max3_f32 v32, v48, v49, v50
    v_max3_f32 v33, v51, v52, v53
    v_max3_f32 v34, v54, v55, v56
    v_max3_f32 v35, v57, v58, v59
    v_max3_f32 v36, v60, v61, v62
    v_max3_f32 v108, v32, v33, v63
    v_max3_f32 v109, v34, v35, v36
    v_max_f32 v108, v108, v109
    v_mov_b32 v109, v108
    s_nop 1
    v_permlane32_swap_b32 v109, v108
    v_max_f32 v108, v108, v109
    v_sub_f32 v48, v48, v108
    v_sub_f32 v49, v49, v108
    v_sub_f32 v50, v50, v108
    v_sub_f32 v51, v51, v108
    v_sub_f32 v52, v52, v108
    v_sub_f32 v53, v53, v108
    v_sub_f32 v54, v54, v108
    v_sub_f32 v55, v55, v108
    v_sub_f32 v56, v56, v108
    v_sub_f32 v57, v57, v108
    v_sub_f32 v58, v58, v108
    v_sub_f32 v59, v59, v108
    v_sub_f32 v60, v60, v108
    v_sub_f32 v61, v61, v108
    v_sub_f32 v62, v62, v108
    v_sub_f32 v63, v63, v108
    v_sub_f32 v32, 0, v108
    v_sub_f32 v33, 0, v108
    v_sub_f32 v34, 0, v108
    v_sub_f32 v35, 0, v108
    v_sub_f32 v36, 0, v108
    v_sub_f32 v37, 0, v108
    v_sub_f32 v38, 0, v108
    v_sub_f32 v39, 0, v108
    v_sub_f32 v40, 0, v108
    v_sub_f32 v41, 0, v108
    v_sub_f32 v42, 0, v108
    v_sub_f32 v43, 0, v108
    v_sub_f32 v44, 0, v108
    v_sub_f32 v45, 0, v108
    v_sub_f32 v46, 0, v108
    v_sub_f32 v47, 0, v108
    s_waitcnt vmcnt(0)
    s_mov_b64 exec, 1
    ds_add_u32 v112, v113 offset:4
    s_mov_b64 exec, -1
L_loop:
    s_bitcmp1_b32 s27, s26
    s_cbranch_scc1 L_side
L_body:
    s_cmp_lt_u32 s7, 4
    s_cbranch_scc1 L_pt0
    s_setprio 2
L_pt0:
    v_exp_f32 v48, v48
    v_exp_f32 v49, v49
    v_mfma_f32_32x32x16_bf16 v[88:103], v[28:31], v[84:87], v[88:103]
    s_mov_b64 exec, s[20:21]
    ds_read_b128 v[24:27], v111 offset:5120
    ds_read_b128 v[28:31], v111 offset:5632
    s_mov_b64 exec, -1
    v_exp_f32 v50, v50
    v_exp_f32 v51, v51
    v_cvt_pk_bf16_f32 v80, v48, v49
    v_exp_f32 v52, v52
    v_exp_f32 v53, v53
    v_cvt_pk_bf16_f32 v81, v50, v51
    s_waitcnt lgkmcnt(2)
    v_exp_f32 v54, v54
    v_exp_f32 v55, v55
    v_mfma_f32_32x32x16_bf16 v[64:79], v[12:15], v[4:7], v[32:47]
    ds_read_b128 v[8:11], v110 offset:2048
    v_cvt_pk_bf16_f32 v82, v52, v53
    v_exp_f32 v56, v56
    v_exp_f32 v57, v57
    v_cvt_pk_bf16_f32 v83, v54, v55
    v_exp_f32 v58, v58
    v_exp_f32 v59, v59
    v_exp_f32 v60, v60
    v_cvt_pk_bf16_f32 v84, v56, v57
    v_mfma_f32_32x32x16_bf16 v[88:103], v[16:19], v[80:83], v[88:103]
    v_exp_f32 v61, v61
    v_cvt_pk_bf16_f32 v85, v58, v59
    v_exp_f32 v62, v62
    v_exp_f32 v63, v63
    v_cvt_pk_bf16_f32 v86, v60, v61
    v_cvt_pk_bf16_f32 v87, v62, v63
    v_exp_f32 v64, v64
    v_exp_f32 v65, v65
    v_mfma_f32_32x32x16_bf16 v[88:103], v[20:23], v[84:87], v[88:103]
    s_mov_b64 exec, s[20:21]
    ds_read_b128 v[16:19], v111 offset:6144
    ds_read_b128 v[20:23], v111 offset:6656
    s_mov_b64 exec, -1
    v_exp_f32 v66, v66
    v_exp_f32 v67, v67
    v_cvt_pk_bf16_f32 v80, v64, v65
    v_exp_f32 v68, v68
    v_exp_f32 v69, v69
    v_cvt_pk_bf16_f32 v81, v66, v67
    s_waitcnt lgkmcnt(2)
    v_exp_f32 v70, v70
    v_exp_f32 v71, v71
    v_mfma_f32_32x32x16_bf16 v[48:63], v[8:11], v[4:7], v[32:47]
    ds_read_b128 v[12:15], v110 offset:3072
    v_cvt_pk_bf16_f32 v82, v68, v69
    v_exp_f32 v72, v72
    v_exp_f32 v73, v73
    v_cvt_pk_bf16_f32 v83, v70, v71
    v_exp_f32 v74, v74
    v_exp_f32 v75, v75
    v_exp_f32 v76, v76
    v_cvt_pk_bf16_f32 v84, v72, v73
    v_mfma_f32_32x32x16_bf16 v[88:103], v[24:27], v[80:83], v[88:103]
    v_exp_f32 v77, v77
    v_cvt_pk_bf16_f32 v85, v74, v75
    v_exp_f32 v78, v78
    v_exp_f32 v79, v79
    v_cvt_pk_bf16_f32 v86, v76, v77
    v_cvt_pk_bf16_f32 v87, v78, v79
    v_exp_f32 v48, v48
    v_exp_f32 v49, v49
    v_mfma_f32_32x32x16_bf16 v[88:103], v[28:31], v[84:87], v[88:103]
    s_mov_b64 exec, s[20:21]
    ds_read_b128 v[24:27], v111 offset:7168
    ds_read_b128 v[28:31], v111 offset:7680
    s_mov_b64 exec, -1
    v_exp_f32 v50, v50
    v_exp_f32 v51, v51
    v_cvt_pk_bf16_f32 v80, v48, v49
    v_exp_f32 v52, v52
    v_exp_f32 v53, v53
    v_cvt_pk_bf16_f32 v81, v50, v51
    s_waitcnt lgkmcnt(2)
    v_exp_f32 v54, v54
    v_exp_f32 v55, v55
    v_mfma_f32_32x32x16_bf16 v[64:79], v[12:15], v[4:7], v[32:47]
    ds_read_b128 v[8:11], v110 offset:8192
    v_cvt_pk_bf16_f32 v82, v52, v53
    v_exp_f32 v56, v56
    v_exp_f32 v57, v57
    v_cvt_pk_bf16_f32 v83, v54, v55
    v_exp_f32 v58, v58
    v_exp_f32 v59, v59
    v_exp_f32 v60, v60
    v_cvt_pk_bf16_f32 v84, v56, v57
    v_mfma_f32_32x32x16_bf16 v[88:103], v[16:19], v[80:83], v[88:103]
    v_exp_f32 v61, v61
    v_cvt_pk_bf16_f32 v85, v58, v59
    v_exp_f32 v62, v62
    v_exp_f32 v63, v63
    v_cvt_pk_bf16_f32 v86, v60, v61
    v_cvt_pk_bf16_f32 v87, v62, v63
    s_cmp_lt_u32 s7, 4
    s_cbranch_scc1 L_pt3
    s_setprio 1
L_pt3:
    v_exp_f32 v64, v64
    v_exp_f32 v65, v65
    v_mfma_f32_32x32x16_bf16 v[88:103], v[20:23], v[84:87], v[88:103]
    s_mov_b64 exec, s[20:21]
    ds_read_b128 v[16:19], v111 offset:12288
    ds_read_b128 v[20:23], v111 offset:12800
    s_mov_b64 exec, -1
    v_exp_f32 v66, v66
    v_exp_f32 v67, v67
    v_cvt_pk_bf16_f32 v80, v64, v65
    v_exp_f32 v68, v68
    v_exp_f32 v69, v69
    v_cvt_pk_bf16_f32 v81, v66, v67
    s_waitcnt lgkmcnt(2)
    v_exp_f32 v70, v70
    v_exp_f32 v71, v71
    v_mfma_f32_32x32x16_bf16 v[48:63], v[8:11], v[4:7], v[32:47]
    ds_read_b128 v[12:15], v110 offset:9216
    v_cvt_pk_bf16_f32 v82, v68, v69
    v_exp_f32 v72, v72
    v_exp_f32 v73, v73
    v_cvt_pk_bf16_f32 v83, v70, v71
    v_exp_f32 v74, v74
    v_exp_f32 v75, v75
    v_exp_f32 v76, v76
    v_cvt_pk_bf16_f32 v84, v72, v73
    v_mfma_f32_32x32x16_bf16 v[88:103], v[24:27], v[80:83], v[88:103]
    v_exp_f32 v77, v77
    v_cvt_pk_bf16_f32 v85, v74, v75
    v_exp_f32 v78, v78
    v_exp_f32 v79, v79
    v_cvt_pk_bf16_f32 v86, v76, v77
    v_cvt_pk_bf16_f32 v87, v78, v79
    v_add_u32 v110, 8192, v110
    v_add_u32 v111, 8192, v111
L_next:
    s_add_u32 s26, s26, 1
    s_cmp_lt_u32 s26, 16
    s_cbranch_scc1 L_loop
    v_mfma_f32_32x32x16_bf16 v[88:103], v[28:31], v[84:87], v[88:103]
    v_mov_b32 v114, 0x5d800000
    s_nop 10
    v_rcp_f32 v108, v96
    v_add_f32 v109, |v88|, |v89|
    v_add_f32 v109, v109, |v90|
    v_add_f32 v109, v109, |v91|
    v_add_f32 v109, v109, |v92|
    v_add_f32 v109, v109, |v93|
    v_add_f32 v109, v109, |v94|
    v_add_f32 v109, v109, |v95|
    v_fma_f32 v109, v109, 0, v96
    v_cmp_nle_f32 vcc, v109, v114
    s_nop 0
    s_cmp_lg_u64 vcc, 0
    s_cbranch_scc1 L_fb
L_fin:
    v_mul_f32 v88, v88, v108
    v_mul_f32 v89, v89, v108
    v_mul_f32 v90, v90, v108
    v_mul_f32 v91, v91, v108
    v_mul_f32 v92, v92, v108
    v_mul_f32 v93, v93, v108
    v_mul_f32 v94, v94, v108
    v_mul_f32 v95, v95, v108
    v_cvt_pk_bf16_f32 v80, v88, v89
    v_cvt_pk_bf16_f32 v81, v90, v91
    v_cvt_pk_bf16_f32 v82, v92, v93
    v_cvt_pk_bf16_f32 v83, v94, v95
    v_min_u32 v80, -2, v80
    v_min_u32 v81, -2, v81
    v_min_u32 v82, -2, v82
    v_min_u32 v83, -2, v83
    buffer_store_dwordx4 v[80:83], v104, s[48:51], s22 offen sc1
    s_mov_b64 exec, 0xff
    buffer_store_dwordx2 v[116:117], v118, s[48:51], s10 offen sc1
    s_mov_b64 exec, -1
    s_endpgm
L_side:
    s_cmp_eq_u32 s26, 7
    s_cbranch_scc1 L_sd7
    s_cmp_eq_u32 s26, 1
    s_cbranch_scc1 L_sd1
    s_cmp_eq_u32 s26, 4
    s_cbranch_scc1 L_sd4
    s_cmp_eq_u32 s26, 8
    s_cbranch_scc1 L_sd8
    s_waitcnt vmcnt(0)
    s_mov_b64 exec, 1
    ds_add_u32 v112, v113 offset:20
    s_mov_b64 exec, -1
    s_branch L_body
L_sd1:
    s_mov_b32 s64, 0
    s_branch L_s1_1
L_s1:
L_s1_1:
    ds_read_b32 v114, v112 offset:4
    s_add_u32 s64, s64, 1
    s_waitcnt lgkmcnt(0)
    v_readfirstlane_b32 s25, v114
    s_lshr_b32 s65, s64, 18
    s_add_u32 s25, s25, s65
    s_cmp_lt_u32 s25, 8
    s_cbranch_scc1 L_s1
    s_branch L_body
L_sd4:
    s_mov_b32 s64, 0
    s_branch L_s2_1
L_s2:
    s_sleep 1
L_s2_1:
    ds_read_b32 v114, v112 offset:8
    s_add_u32 s64, s64, 1
    s_waitcnt lgkmcnt(0)
    v_readfirstlane_b32 s25, v114
    s_lshr_b32 s65, s64, 18
    s_add_u32 s25, s25, s65
    s_cmp_lt_u32 s25, 4
    s_cbranch_scc1 L_s2
    s_branch L_body
L_sd8:
    buffer_store_dwordx4 v[120:123], v104, s[48:51], s22 offen sc1
    s_mov_b32 s64, 0
    s_branch L_s3_1
L_s3:
    s_sleep 1
L_s3_1:
    ds_read_b32 v114, v112 offset:12
    s_add_u32 s64, s64, 1
    s_waitcnt lgkmcnt(0)
    v_readfirstlane_b32 s25, v114
    s_lshr_b32 s65, s64, 18
    s_add_u32 s25, s25, s65
    s_cmp_lt_u32 s25, 4
    s_cbranch_scc1 L_s3
    s_branch L_body
L_sd7:
    s_cmp_lt_u32 s7, 4
    s_cbranch_scc1 L_pt0w
    s_setprio 2
L_pt0w:
    v_exp_f32 v48, v48
    v_exp_f32 v49, v49
    v_mfma_f32_32x32x16_bf16 v[88:103], v[28:31], v[84:87], v[88:103]
    s_mov_b64 exec, s[20:21]
    ds_read_b128 v[24:27], v111 offset:5120
    ds_read_b128 v[28:31], v111 offset:5632
    s_mov_b64 exec, -1
    v_exp_f32 v50, v50
    v_exp_f32 v51, v51
    v_cvt_pk_bf16_f32 v80, v48, v49
    v_exp_f32 v52, v52
    v_exp_f32 v53, v53
    v_cvt_pk_bf16_f32 v81, v50, v51
    s_waitcnt lgkmcnt(2)
    v_exp_f32 v54, v54
    v_exp_f32 v55, v55
    v_mfma_f32_32x32x16_bf16 v[64:79], v[12:15], v[4:7], v[32:47]
    ds_read_b128 v[8:11], v110 offset:2048
    v_cvt_pk_bf16_f32 v82, v52, v53
    v_exp_f32 v56, v56
    v_exp_f32 v57, v57
    v_cvt_pk_bf16_f32 v83, v54, v55
    v_exp_f32 v58, v58
    v_exp_f32 v59, v59
    v_exp_f32 v60, v60
    v_cvt_pk_bf16_f32 v84, v56, v57
    v_mfma_f32_32x32x16_bf16 v[88:103], v[16:19], v[80:83], v[88:103]
    v_exp_f32 v61, v61
    v_cvt_pk_bf16_f32 v85, v58, v59
    v_exp_f32 v62, v62
    v_exp_f32 v63, v63
    v_cvt_pk_bf16_f32 v86, v60, v61
    v_cvt_pk_bf16_f32 v87, v62, v63
    v_exp_f32 v64, v64
    v_exp_f32 v65, v65
    v_mfma_f32_32x32x16_bf16 v[88:103], v[20:23], v[84:87], v[88:103]
    s_mov_b64 exec, s[20:21]
    ds_read_b128 v[16:19], v111 offset:6144
    ds_read_b128 v[20:23], v111 offset:6656
    s_mov_b64 exec, -1
    v_exp_f32 v66, v66
    v_exp_f32 v67, v67
    v_cvt_pk_bf16_f32 v80, v64, v65
    v_exp_f32 v68, v68
    v_exp_f32 v69, v69
    v_cvt_pk_bf16_f32 v81, v66, v67
    s_waitcnt lgkmcnt(2)
    v_exp_f32 v70, v70
    v_exp_f32 v71, v71
    v_mfma_f32_32x32x16_bf16 v[48:63], v[8:11], v[4:7], v[32:47]
    ds_read_b128 v[12:15], v110 offset:3072
    v_cvt_pk_bf16_f32 v82, v68, v69
    v_exp_f32 v72, v72
    v_exp_f32 v73, v73
    v_cvt_pk_bf16_f32 v83, v70, v71
    v_exp_f32 v74, v74
    v_exp_f32 v75, v75
    v_exp_f32 v76, v76
    v_cvt_pk_bf16_f32 v84, v72, v73
    v_mfma_f32_32x32x16_bf16 v[88:103], v[24:27], v[80:83], v[88:103]
    v_exp_f32 v77, v77
    v_cvt_pk_bf16_f32 v85, v74, v75
    v_exp_f32 v78, v78
    v_exp_f32 v79, v79
    v_cvt_pk_bf16_f32 v86, v76, v77
    v_cvt_pk_bf16_f32 v87, v78, v79
    v_exp_f32 v48, v48
    v_exp_f32 v49, v49
    v_mfma_f32_32x32x16_bf16 v[88:103], v[28:31], v[84:87], v[88:103]
    s_mov_b64 exec, s[20:21]
    ds_read_b128 v[24:27], v111 offset:7168
    ds_read_b128 v[28:31], v111 offset:7680
    s_mov_b64 exec, -1
    v_exp_f32 v50, v50
    v_exp_f32 v51, v51
    v_cvt_pk_bf16_f32 v80, v48, v49
    v_exp_f32 v52, v52
    v_exp_f32 v53, v53
    v_cvt_pk_bf16_f32 v81, v50, v51
    s_waitcnt lgkmcnt(2)
    v_exp_f32 v54, v54
    v_exp_f32 v55, v55
    v_mfma_f32_32x32x16_bf16 v[64:79], v[12:15], v[4:7], v[32:47]
    ds_read_b128 v[8:11], v104 offset:0
    v_cvt_pk_bf16_f32 v82, v52, v53
    v_exp_f32 v56, v56
    v_exp_f32 v57, v57
    v_cvt_pk_bf16_f32 v83, v54, v55
    v_exp_f32 v58, v58
    v_exp_f32 v59, v59
    v_exp_f32 v60, v60
    v_cvt_pk_bf16_f32 v84, v56, v57
    v_mfma_f32_32x32x16_bf16 v[88:103], v[16:19], v[80:83], v[88:103]
    v_exp_f32 v61, v61
    v_cvt_pk_bf16_f32 v85, v58, v59
    v_exp_f32 v62, v62
    v_exp_f32 v63, v63
    v_cvt_pk_bf16_f32 v86, v60, v61
    v_cvt_pk_bf16_f32 v87, v62, v63
    s_cmp_lt_u32 s7, 4
    s_cbranch_scc1 L_pt3w
    s_setprio 1
L_pt3w:
    v_exp_f32 v64, v64
    v_exp_f32 v65, v65
    v_mfma_f32_32x32x16_bf16 v[88:103], v[20:23], v[84:87], v[88:103]
    s_mov_b64 exec, s[20:21]
    ds_read_b128 v[16:19], v106 offset:4096
    ds_read_b128 v[20:23], v106 offset:4608
    s_mov_b64 exec, -1
    v_exp_f32 v66, v66
    v_exp_f32 v67, v67
    v_cvt_pk_bf16_f32 v80, v64, v65
    v_exp_f32 v68, v68
    v_exp_f32 v69, v69
    v_cvt_pk_bf16_f32 v81, v66, v67
    s_waitcnt lgkmcnt(2)
    v_exp_f32 v70, v70
    v_exp_f32 v71, v71
    v_mfma_f32_32x32x16_bf16 v[48:63], v[8:11], v[4:7], v[32:47]
    ds_read_b128 v[12:15], v104 offset:1024
    v_cvt_pk_bf16_f32 v82, v68, v69
    v_exp_f32 v72, v72
    v_exp_f32 v73, v73
    v_cvt_pk_bf16_f32 v83, v70, v71
    v_exp_f32 v74, v74
    v_exp_f32 v75, v75
    v_exp_f32 v76, v76
    v_cvt_pk_bf16_f32 v84, v72, v73
    v_mfma_f32_32x32x16_bf16 v[88:103], v[24:27], v[80:83], v[88:103]
    v_exp_f32 v77, v77
    v_cvt_pk_bf16_f32 v85, v74, v75
    v_exp_f32 v78, v78
    v_exp_f32 v79, v79
    v_cvt_pk_bf16_f32 v86, v76, v77
    v_cvt_pk_bf16_f32 v87, v78, v79
    v_mov_b32 v110, v104
    v_mov_b32 v111, v106
    s_branch L_next
L_fb:
    s_waitcnt lgkmcnt(0)
    s_add_u32 s12, s13, 2097152
    v_mov_b32 v108, 0xff800000
    s_mov_b32 s26, 0
L_mx:
    buffer_load_dwordx4 v[32:35], v104, s[48:51], s12 offen offset:0 sc1
    buffer_load_dwordx4 v[36:39], v104, s[48:51], s12 offen offset:1024 sc1
    buffer_load_dwordx4 v[40:43], v104, s[48:51], s12 offen offset:2048 sc1
    buffer_load_dwordx4 v[44:47], v104, s[48:51], s12 offen offset:3072 sc1
    s_waitcnt vmcnt(3)
    v_mfma_f32_32x32x16_bf16 v[48:63], v[32:35], v[4:7], 0
    s_nop 11
    v_max3_f32 v108, v108, v48, v49
    v_max3_f32 v108, v108, v50, v51
    v_max3_f32 v108, v108, v52, v53
    v_max3_f32 v108, v108, v54, v55
    v_max3_f32 v108, v108, v56, v57
    v_max3_f32 v108, v108, v58, v59
    v_max3_f32 v108, v108, v60, v61
    v_max3_f32 v108, v108, v62, v63
    s_waitcnt vmcnt(2)
    v_mfma_f32_32x32x16_bf16 v[64:79], v[36:39], v[4:7], 0
    s_nop 11
    v_max3_f32 v108, v108, v64, v65
    v_max3_f32 v108, v108, v66, v67
    v_max3_f32 v108, v108, v68, v69
    v_max3_f32 v108, v108, v70, v71
    v_max3_f32 v108, v108, v72, v73
    v_max3_f32 v108, v108, v74, v75
    v_max3_f32 v108, v108, v76, v77
    v_max3_f32 v108, v108, v78, v79
    s_waitcnt vmcnt(1)
    v_mfma_f32_32x32x16_bf16 v[48:63], v[40:43], v[4:7], 0
    s_nop 11
    v_max3_f32 v108, v108, v48, v49
    v_max3_f32 v108, v108, v50, v51
    v_max3_f32 v108, v108, v52, v53
    v_max3_f32 v108, v108, v54, v55
    v_max3_f32 v108, v108, v56, v57
    v_max3_f32 v108, v108, v58, v59
    v_max3_f32 v108, v108, v60, v61
    v_max3_f32 v108, v108, v62, v63
    s_waitcnt vmcnt(0)
    v_mfma_f32_32x32x16_bf16 v[64:79], v[44:47], v[4:7], 0
    s_nop 11
    v_max3_f32 v108, v108, v64, v65
    v_max3_f32 v108, v108, v66, v67
    v_max3_f32 v108, v108, v68, v69
    v_max3_f32 v108, v108, v70, v71
    v_max3_f32 v108, v108, v72, v73
    v_max3_f32 v108, v108, v74, v75
    v_max3_f32 v108, v108, v76, v77
    v_max3_f32 v108, v108, v78, v79
    s_add_u32 s12, s12, 4096
    s_add_u32 s26, s26, 1
    s_cmp_lt_u32 s26, 16
    s_cbranch_scc1 L_mx
    v_mov_b32 v109, v108
    s_nop 1
    v_permlane32_swap_b32 v109, v108
    v_max_f32 v108, v108, v109
    v_sub_f32 v32, 0, v108
    v_sub_f32 v33, 0, v108
    v_sub_f32 v34, 0, v108
    v_sub_f32 v35, 0, v108
    v_sub_f32 v36, 0, v108
    v_sub_f32 v37, 0, v108
    v_sub_f32 v38, 0, v108
    v_sub_f32 v39, 0, v108
    v_sub_f32 v40, 0, v108
    v_sub_f32 v41, 0, v108
    v_sub_f32 v42, 0, v108
    v_sub_f32 v43, 0, v108
    v_sub_f32 v44, 0, v108
    v_sub_f32 v45, 0, v108
    v_sub_f32 v46, 0, v108
    v_sub_f32 v47, 0, v108
    v_mov_b32 v88, 0
    v_mov_b32 v89, 0
    v_mov_b32 v90, 0
    v_mov_b32 v91, 0
    v_mov_b32 v92, 0
    v_mov_b32 v93, 0
    v_mov_b32 v94, 0
    v_mov_b32 v95, 0
    v_mov_b32 v96, 0
    v_mov_b32 v97, 0
    v_mov_b32 v98, 0
    v_mov_b32 v99, 0
    v_mov_b32 v100, 0
    v_mov_b32 v101, 0
    v_mov_b32 v102, 0
    v_mov_b32 v103, 0
    s_add_u32 s12, s13, 2097152
    s_add_u32 s11, s13, 4194304
    s_mov_b32 s26, 0
L_f2:
    buffer_load_dwordx4 v[8:11], v104, s[48:51], s12 offen offset:0 sc1
    s_mov_b64 exec, s[20:21]
    buffer_load_dwordx4 v[16:19], v106, s[48:51], s11 offen offset:0 sc1
    buffer_load_dwordx4 v[20:23], v106, s[48:51], s11 offen offset:512 sc1
    s_mov_b64 exec, -1
    buffer_load_dwordx4 v[12:15], v104, s[48:51], s12 offen offset:1024 sc1
    s_mov_b64 exec, s[20:21]
    buffer_load_dwordx4 v[24:27], v106, s[48:51], s11 offen offset:1024 sc1
    buffer_load_dwordx4 v[28:31], v106, s[48:51], s11 offen offset:1536 sc1
    s_mov_b64 exec, -1
    s_waitcnt vmcnt(3)
    v_mfma_f32_32x32x16_bf16 v[48:63], v[8:11], v[4:7], v[32:47]
    s_nop 11
    v_exp_f32 v48, v48
    v_exp_f32 v49, v49
    v_exp_f32 v50, v50
    v_exp_f32 v51, v51
    v_exp_f32 v52, v52
    v_exp_f32 v53, v53
    v_exp_f32 v54, v54
    v_exp_f32 v55, v55
    v_exp_f32 v56, v56
    v_exp_f32 v57, v57
    v_exp_f32 v58, v58
    v_exp_f32 v59, v59
    v_exp_f32 v60, v60
    v_exp_f32 v61, v61
    v_exp_f32 v62, v62
    v_exp_f32 v63, v63
    v_cvt_pk_bf16_f32 v80, v48, v49
    v_cvt_pk_bf16_f32 v81, v50, v51
    v_cvt_pk_bf16_f32 v82, v52, v53
    v_cvt_pk_bf16_f32 v83, v54, v55
    v_cvt_pk_bf16_f32 v84, v56, v57
    v_cvt_pk_bf16_f32 v85, v58, v59
    v_cvt_pk_bf16_f32 v86, v60, v61
    v_cvt_pk_bf16_f32 v87, v62, v63
    v_mfma_f32_32x32x16_bf16 v[88:103], v[16:19], v[80:83], v[88:103]
    s_nop 0
    v_mfma_f32_32x32x16_bf16 v[88:103], v[20:23], v[84:87], v[88:103]
    s_waitcnt vmcnt(0)
    v_mfma_f32_32x32x16_bf16 v[64:79], v[12:15], v[4:7], v[32:47]
    s_nop 11
    v_exp_f32 v64, v64
    v_exp_f32 v65, v65
    v_exp_f32 v66, v66
    v_exp_f32 v67, v67
    v_exp_f32 v68, v68
    v_exp_f32 v69, v69
    v_exp_f32 v70, v70
    v_exp_f32 v71, v71
    v_exp_f32 v72, v72
    v_exp_f32 v73, v73
    v_exp_f32 v74, v74
    v_exp_f32 v75, v75
    v_exp_f32 v76, v76
    v_exp_f32 v77, v77
    v_exp_f32 v78, v78
    v_exp_f32 v79, v79
    v_cvt_pk_bf16_f32 v80, v64, v65
    v_cvt_pk_bf16_f32 v81, v66, v67
    v_cvt_pk_bf16_f32 v82, v68, v69
    v_cvt_pk_bf16_f32 v83, v70, v71
    v_cvt_pk_bf16_f32 v84, v72, v73
    v_cvt_pk_bf16_f32 v85, v74, v75
    v_cvt_pk_bf16_f32 v86, v76, v77
    v_cvt_pk_bf16_f32 v87, v78, v79
    v_mfma_f32_32x32x16_bf16 v[88:103], v[24:27], v[80:83], v[88:103]
    s_nop 0
    v_mfma_f32_32x32x16_bf16 v[88:103], v[28:31], v[84:87], v[88:103]
    s_add_u32 s12, s12, 2048
    s_add_u32 s11, s11, 2048
    s_add_u32 s26, s26, 1
    s_cmp_lt_u32 s26, 32
    s_cbranch_scc1 L_f2
    s_nop 6
    v_rcp_f32 v108, v96
    s_nop 0
    s_branch L_fin
L_B2:
    s_lshl_b32 s9, s12, 14
    s_lshl_b32 s10, s59, 13
    s_sub_u32 s9, s9, s10
    v_add_u32 v80, s9, v8
    v_add_u32 v81, s9, v9
    v_add_u32 v82, s9, v10
    v_add_u32 v83, s9, v11
    s_lshl_b32 s9, s12, 8
    s_add_u32 s9, s9, 155648
    v_lshl_add_u32 v84, v4, 4, s9
    ds_read_b128 v[16:19], v84 offset:0
    ds_read_b128 v[20:23], v80 offset:0
    ds_read_b128 v[24:27], v80 offset:4096
    ds_read_b128 v[28:31], v84 offset:32
    ds_read_b128 v[32:35], v81 offset:0
    ds_read_b128 v[36:39], v81 offset:4096
    s_waitcnt lgkmcnt(3)
    v_mfma_f32_32x32x16_bf16 v[96:111], v[16:19], v[20:23], 0
    v_mfma_f32_32x32x16_bf16 v[112:127], v[16:19], v[24:27], 0
    ds_read_b128 v[16:19], v84 offset:64
    ds_read_b128 v[20:23], v82 offset:0
    ds_read_b128 v[24:27], v82 offset:4096
    s_waitcnt lgkmcnt(3)
    v_mfma_f32_32x32x16_bf16 v[96:111], v[28:31], v[32:35], v[96:111]
    v_mfma_f32_32x32x16_bf16 v[112:127], v[28:31], v[36:39], v[112:127]
    ds_read_b128 v[28:31], v84 offset:96
    ds_read_b128 v[32:35], v83 offset:0
    ds_read_b128 v[36:39], v83 offset:4096
    s_waitcnt lgkmcnt(3)
    v_mfma_f32_32x32x16_bf16 v[96:111], v[16:19], v[20:23], v[96:111]
    v_mfma_f32_32x32x16_bf16 v[112:127], v[16:19], v[24:27], v[112:127]
    ds_read_b128 v[16:19], v84 offset:128
    ds_read_b128 v[20:23], v80 offset:8192
    ds_read_b128 v[24:27], v80 offset:12288
    s_waitcnt lgkmcnt(3)
    v_mfma_f32_32x32x16_bf16 v[96:111], v[28:31], v[32:35], v[96:111]
    v_mfma_f32_32x32x16_bf16 v[112:127], v[28:31], v[36:39], v[112:127]
    ds_read_b128 v[28:31], v84 offset:160
    ds_read_b128 v[32:35], v81 offset:8192
    ds_read_b128 v[36:39], v81 offset:12288
    s_waitcnt lgkmcnt(3)
    v_mfma_f32_32x32x16_bf16 v[96:111], v[16:19], v[20:23], v[96:111]
    v_mfma_f32_32x32x16_bf16 v[112:127], v[16:19], v[24:27], v[112:127]
    ds_read_b128 v[16:19], v84 offset:192
    ds_read_b128 v[20:23], v82 offset:8192
    ds_read_b128 v[24:27], v82 offset:12288
    s_waitcnt lgkmcnt(3)
    v_mfma_f32_32x32x16_bf16 v[96:111], v[28:31], v[32:35], v[96:111]
    v_mfma_f32_32x32x16_bf16 v[112:127], v[28:31], v[36:39], v[112:127]
    ds_read_b128 v[28:31], v84 offset:224
    ds_read_b128 v[32:35], v83 offset:8192
    ds_read_b128 v[36:39], v83 offset:12288
    s_waitcnt lgkmcnt(3)
    v_mfma_f32_32x32x16_bf16 v[96:111], v[16:19], v[20:23], v[96:111]
    v_mfma_f32_32x32x16_bf16 v[112:127], v[16:19], v[24:27], v[112:127]
    s_waitcnt lgkmcnt(0)
    v_mfma_f32_32x32x16_bf16 v[96:111], v[28:31], v[32:35], v[96:111]
    v_mfma_f32_32x32x16_bf16 v[112:127], v[28:31], v[36:39], v[112:127]
    v_lshlrev_b32 v5, 4, v1
    v_mov_b32 v160, 163776
    v_mov_b32 v161, 1
    s_lshl_b32 s9, s12, 9
    s_add_u32 s9, s9, 157696
    v_lshl_add_u32 v84, v1, 2, s9
    s_nop 4
    ds_write_b32 v84, v96
    ds_write_b32 v84, v112 offset:256
    s_cmp_eq_u32 s61, 3
    s_cbranch_scc1 L_bi1
    s_waitcnt vmcnt(10)
    ds_read_b64_tr_b16 v[16:17], v12 offset:24576
    ds_read_b64_tr_b16 v[18:19], v12 offset:25088
    ds_read_b64_tr_b16 v[20:21], v13 offset:24576
    ds_read_b64_tr_b16 v[22:23], v13 offset:25088
    ds_read_b128 v[24:27], v8 offset:0
    ds_read_b128 v[28:31], v8 offset:4096
    s_waitcnt lgkmcnt(0)
    v_mfma_f32_32x32x16_bf16 v[96:111], v[16:19], v[24:27], v[48:63]
    s_waitcnt vmcnt(8)
    ds_read_b64_tr_b16 v[32:33], v12 offset:26624
    ds_read_b64_tr_b16 v[34:35], v12 offset:27136
    ds_read_b64_tr_b16 v[36:37], v13 offset:26624
    v_mfma_f32_32x32x16_bf16 v[112:127], v[16:19], v[28:31], v[48:63]
    ds_read_b64_tr_b16 v[38:39], v13 offset:27136
    ds_read_b128 v[40:43], v9 offset:0
    ds_read_b128 v[44:47], v9 offset:4096
    v_mfma_f32_32x32x16_bf16 v[128:143], v[20:23], v[24:27], v[64:79]
    s_add_u32 m0, s13, 0
    s_nop 0
    buffer_load_dwordx4 v14, s[52:55], s14 offen lds
    v_mfma_f32_32x32x16_bf16 v[144:159], v[20:23], v[28:31], v[64:79]
    buffer_load_dwordx4 v15, s[52:55], s14 offen offset:1024 lds
    s_add_u32 s14, s14, 57344
    s_waitcnt lgkmcnt(0)
    v_mfma_f32_32x32x16_bf16 v[96:111], v[32:35], v[40:43], v[96:111]
    s_waitcnt vmcnt(8)
    ds_read_b64_tr_b16 v[16:17], v12 offset:28672
    ds_read_b64_tr_b16 v[18:19], v12 offset:29184
    ds_read_b64_tr_b16 v[20:21], v13 offset:28672
    v_mfma_f32_32x32x16_bf16 v[112:127], v[32:35], v[44:47], v[112:127]
    ds_read_b64_tr_b16 v[22:23], v13 offset:29184
    ds_read_b128 v[24:27], v10 offset:0
    ds_read_b128 v[28:31], v10 offset:4096
    v_mfma_f32_32x32x16_bf16 v[128:143], v[36:39], v[40:43], v[128:143]
    s_add_u32 m0, s13, 2048
    s_nop 0
    buffer_load_dwordx4 v14, s[52:55], s14 offen lds
    v_mfma_f32_32x32x16_bf16 v[144:159], v[36:39], v[44:47], v[144:159]
    buffer_load_dwordx4 v15, s[52:55], s14 offen offset:1024 lds
    s_add_u32 s14, s14, 57344
    s_waitcnt lgkmcnt(0)
    v_mfma_f32_32x32x16_bf16 v[96:111], v[16:19], v[24:27], v[96:111]
    s_waitcnt vmcnt(8)
    ds_read_b64_tr_b16 v[32:33], v12 offset:0
    ds_read_b64_tr_b16 v[34:35], v12 offset:512
    ds_read_b64_tr_b16 v[36:37], v13 offset:0
    v_mfma_f32_32x32x16_bf16 v[112:127], v[16:19], v[28:31], v[112:127]
    ds_read_b64_tr_b16 v[38:39], v13 offset:512
    ds_read_b128 v[40:43], v11 offset:0
    ds_read_b128 v[44:47], v11 offset:4096
    v_mfma_f32_32x32x16_bf16 v[128:143], v[20:23], v[24:27], v[128:143]
    s_add_u32 s14, s58, 2
    s_and_b32 s14, s14, 7
    s_mul_i32 s14, s14, 229376
    s_add_u32 s14, s14, s15
    s_add_u32 m0, s13, 4096
    s_nop 0
    buffer_load_dwordx4 v14, s[52:55], s14 offen lds
    v_mfma_f32_32x32x16_bf16 v[144:159], v[20:23], v[28:31], v[144:159]
    buffer_load_dwordx4 v15, s[52:55], s14 offen offset:1024 lds
    s_add_u32 s14, s14, 57344
    s_waitcnt lgkmcnt(0)
    v_mfma_f32_32x32x16_bf16 v[96:111], v[32:35], v[40:43], v[96:111]
    s_waitcnt vmcnt(8)
    ds_read_b64_tr_b16 v[16:17], v12 offset:2048
    ds_read_b64_tr_b16 v[18:19], v12 offset:2560
    ds_read_b64_tr_b16 v[20:21], v13 offset:2048
    v_mfma_f32_32x32x16_bf16 v[112:127], v[32:35], v[44:47], v[112:127]
    ds_read_b64_tr_b16 v[22:23], v13 offset:2560
    ds_read_b128 v[24:27], v8 offset:8192
    ds_read_b128 v[28:31], v8 offset:12288
    v_mfma_f32_32x32x16_bf16 v[128:143], v[36:39], v[40:43], v[128:143]
    s_add_u32 m0, s62, 0
    s_nop 0
    buffer_load_dwordx4 v14, s[52:55], s14 offen lds
    v_mfma_f32_32x32x16_bf16 v[144:159], v[36:39], v[44:47], v[144:159]
    buffer_load_dwordx4 v15, s[52:55], s14 offen offset:1024 lds
    s_add_u32 s14, s14, 57344
    s_waitcnt lgkmcnt(0)
    v_mfma_f32_32x32x16_bf16 v[96:111], v[16:19], v[24:27], v[96:111]
    s_waitcnt vmcnt(8)
    ds_read_b64_tr_b16 v[32:33], v12 offset:4096
    ds_read_b64_tr_b16 v[34:35], v12 offset:4608
    ds_read_b64_tr_b16 v[36:37], v13 offset:4096
    v_mfma_f32_32x32x16_bf16 v[112:127], v[16:19], v[28:31], v[112:127]
    ds_read_b64_tr_b16 v[38:39], v13 offset:4608
    ds_read_b128 v[40:43], v9 offset:8192
    ds_read_b128 v[44:47], v9 offset:12288
    v_mfma_f32_32x32x16_bf16 v[128:143], v[20:23], v[24:27], v[128:143]
    s_add_u32 m0, s62, 2048
    s_nop 0
    buffer_load_dwordx4 v14, s[52:55], s14 offen lds
    v_mfma_f32_32x32x16_bf16 v[144:159], v[20:23], v[28:31], v[144:159]
    buffer_load_dwordx4 v15, s[52:55], s14 offen offset:1024 lds
    s_add_u32 s14, s14, 57344
    s_waitcnt lgkmcnt(0)
    v_mfma_f32_32x32x16_bf16 v[96:111], v[32:35], v[40:43], v[96:111]
    s_waitcnt vmcnt(8)
    ds_read_b64_tr_b16 v[16:17], v12 offset:24576
    ds_read_b64_tr_b16 v[18:19], v12 offset:25088
    ds_read_b64_tr_b16 v[20:21], v13 offset:24576
    v_mfma_f32_32x32x16_bf16 v[112:127], v[32:35], v[44:47], v[112:127]
    ds_read_b64_tr_b16 v[22:23], v13 offset:25088
    ds_read_b128 v[24:27], v10 offset:8192
    ds_read_b128 v[28:31], v10 offset:12288
    v_mfma_f32_32x32x16_bf16 v[128:143], v[36:39], v[40:43], v[128:143]
    s_add_u32 m0, s62, 4096
    s_nop 0
    buffer_load_dwordx4 v14, s[52:55], s14 offen lds
    v_mfma_f32_32x32x16_bf16 v[144:159], v[36:39], v[44:47], v[144:159]
    buffer_load_dwordx4 v15, s[52:55], s14 offen offset:1024 lds
    s_add_u32 s14, s14, 57344
    s_waitcnt lgkmcnt(0)
    v_mfma_f32_32x32x16_bf16 v[96:111], v[16:19], v[24:27], v[96:111]
    s_waitcnt vmcnt(8)
    ds_read_b64_tr_b16 v[32:33], v12 offset:26624
    ds_read_b64_tr_b16 v[34:35], v12 offset:27136
    ds_read_b64_tr_b16 v[36:37], v13 offset:26624
    v_mfma_f32_32x32x16_bf16 v[112:127], v[16:19], v[28:31], v[112:127]
    ds_read_b64_tr_b16 v[38:39], v13 offset:27136
    ds_read_b128 v[40:43], v11 offset:8192
    ds_read_b128 v[44:47], v11 offset:12288
    v_mfma_f32_32x32x16_bf16 v[128:143], v[20:23], v[24:27], v[128:143]
    s_add_u32 s14, s58, 3
    s_and_b32 s14, s14, 7
    s_mul_i32 s14, s14, 229376
    s_add_u32 s14, s14, s15
    s_add_u32 m0, s13, 0
    s_nop 0
    buffer_load_dwordx4 v14, s[52:55], s14 offen lds
    v_mfma_f32_32x32x16_bf16 v[144:159], v[20:23], v[28:31], v[144:159]
    buffer_load_dwordx4 v15, s[52:55], s14 offen offset:1024 lds
    s_add_u32 s14, s14, 57344
    s_waitcnt lgkmcnt(0)
    v_mfma_f32_32x32x16_bf16 v[96:111], v[32:35], v[40:43], v[96:111]
    s_waitcnt vmcnt(8)
    ds_read_b64_tr_b16 v[16:17], v12 offset:28672
    ds_read_b64_tr_b16 v[18:19], v12 offset:29184
    ds_read_b64_tr_b16 v[20:21], v13 offset:28672
    v_mfma_f32_32x32x16_bf16 v[112:127], v[32:35], v[44:47], v[112:127]
    ds_read_b64_tr_b16 v[22:23], v13 offset:29184
    ds_read_b128 v[24:27], v8 offset:16384
    ds_read_b128 v[28:31], v8 offset:20480
    v_mfma_f32_32x32x16_bf16 v[128:143], v[36:39], v[40:43], v[128:143]
    s_add_u32 m0, s13, 2048
    s_nop 0
    buffer_load_dwordx4 v14, s[52:55], s14 offen lds
    v_mfma_f32_32x32x16_bf16 v[144:159], v[36:39], v[44:47], v[144:159]
    buffer_load_dwordx4 v15, s[52:55], s14 offen offset:1024 lds
    s_add_u32 s14, s14, 57344
    s_waitcnt lgkmcnt(0)
    v_mfma_f32_32x32x16_bf16 v[96:111], v[16:19], v[24:27], v[96:111]
    s_waitcnt vmcnt(8)
    ds_read_b64_tr_b16 v[32:33], v12 offset:0
    ds_read_b64_tr_b16 v[34:35], v12 offset:512
    ds_read_b64_tr_b16 v[36:37], v13 offset:0
    v_mfma_f32_32x32x16_bf16 v[112:127], v[16:19], v[28:31], v[112:127]
    ds_read_b64_tr_b16 v[38:39], v13 offset:512
    ds_read_b128 v[40:43], v9 offset:16384
    ds_read_b128 v[44:47], v9 offset:20480
    v_mfma_f32_32x32x16_bf16 v[128:143], v[20:23], v[24:27], v[128:143]
    s_add_u32 m0, s13, 4096
    s_nop 0
    buffer_load_dwordx4 v14, s[52:55], s14 offen lds
    v_mfma_f32_32x32x16_bf16 v[144:159], v[20:23], v[28:31], v[144:159]
    buffer_load_dwordx4 v15, s[52:55], s14 offen offset:1024 lds
    s_add_u32 s14, s14, 57344
    s_waitcnt lgkmcnt(0)
    v_mfma_f32_32x32x16_bf16 v[96:111], v[32:35], v[40:43], v[96:111]
    s_waitcnt vmcnt(8)
    ds_read_b64_tr_b16 v[16:17], v12 offset:2048
    ds_read_b64_tr_b16 v[18:19], v12 offset:2560
    ds_read_b64_tr_b16 v[20:21], v13 offset:2048
    v_mfma_f32_32x32x16_bf16 v[112:127], v[32:35], v[44:47], v[112:127]
    ds_read_b64_tr_b16 v[22:23], v13 offset:2560
    ds_read_b128 v[24:27], v10 offset:16384
    ds_read_b128 v[28:31], v10 offset:20480
    v_mfma_f32_32x32x16_bf16 v[128:143], v[36:39], v[40:43], v[128:143]
    s_add_u32 m0, s62, 0
    s_nop 0
    buffer_load_dwordx4 v14, s[52:55], s14 offen lds
    v_mfma_f32_32x32x16_bf16 v[144:159], v[36:39], v[44:47], v[144:159]
    buffer_load_dwordx4 v15, s[52:55], s14 offen offset:1024 lds
    s_add_u32 s14, s14, 57344
    s_waitcnt lgkmcnt(0)
    v_mfma_f32_32x32x16_bf16 v[96:111], v[16:19], v[24:27], v[96:111]
    s_waitcnt vmcnt(8)
    ds_read_b64_tr_b16 v[32:33], v12 offset:4096
    ds_read_b64_tr_b16 v[34:35], v12 offset:4608
    ds_read_b64_tr_b16 v[36:37], v13 offset:4096
    v_mfma_f32_32x32x16_bf16 v[112:127], v[16:19], v[28:31], v[112:127]
    ds_read_b64_tr_b16 v[38:39], v13 offset:4608
    ds_read_b128 v[40:43], v11 offset:16384
    ds_read_b128 v[44:47], v11 offset:20480
    v_mfma_f32_32x32x16_bf16 v[128:143], v[20:23], v[24:27], v[128:143]
    s_add_u32 s14, s58, 4
    s_and_b32 s14, s14, 7
    s_mul_i32 s14, s14, 229376
    s_add_u32 s14, s14, s15
    s_add_u32 m0, s62, 2048
    s_nop 0
    buffer_load_dwordx4 v14, s[52:55], s14 offen lds
    v_mfma_f32_32x32x16_bf16 v[144:159], v[20:23], v[28:31], v[144:159]
    buffer_load_dwordx4 v15, s[52:55], s14 offen offset:1024 lds
    s_add_u32 s14, s14, 57344
    s_waitcnt lgkmcnt(0)
    v_mfma_f32_32x32x16_bf16 v[96:111], v[32:35], v[40:43], v[96:111]
    s_waitcnt vmcnt(8)
    ds_read_b64_tr_b16 v[16:17], v12 offset:24576
    ds_read_b64_tr_b16 v[18:19], v12 offset:25088
    ds_read_b64_tr_b16 v[20:21], v13 offset:24576
    v_mfma_f32_32x32x16_bf16 v[112:127], v[32:35], v[44:47], v[112:127]
    ds_read_b64_tr_b16 v[22:23], v13 offset:25088
    ds_read_b128 v[24:27], v8 offset:24576
    ds_read_b128 v[28:31], v8 offset:28672
    v_mfma_f32_32x32x16_bf16 v[128:143], v[36:39], v[40:43], v[128:143]
    s_add_u32 m0, s62, 4096
    s_nop 0
    buffer_load_dwordx4 v14, s[52:55], s14 offen lds
    v_mfma_f32_32x32x16_bf16 v[144:159], v[36:39], v[44:47], v[144:159]
    buffer_load_dwordx4 v15, s[52:55], s14 offen offset:1024 lds
    s_add_u32 s14, s14, 57344
    s_waitcnt lgkmcnt(0)
    v_mfma_f32_32x32x16_bf16 v[96:111], v[16:19], v[24:27], v[96:111]
    s_waitcnt vmcnt(8)
    ds_read_b64_tr_b16 v[32:33], v12 offset:26624
    ds_read_b64_tr_b16 v[34:35], v12 offset:27136
    ds_read_b64_tr_b16 v[36:37], v13 offset:26624
    v_mfma_f32_32x32x16_bf16 v[112:127], v[16:19], v[28:31], v[112:127]
    ds_read_b64_tr_b16 v[38:39], v13 offset:27136
    ds_read_b128 v[40:43], v9 offset:24576
    ds_read_b128 v[44:47], v9 offset:28672
    v_mfma_f32_32x32x16_bf16 v[128:143], v[20:23], v[24:27], v[128:143]
    s_add_u32 m0, s13, 0
    s_nop 0
    buffer_load_dwordx4 v14, s[52:55], s14 offen lds
    v_mfma_f32_32x32x16_bf16 v[144:159], v[20:23], v[28:31], v[144:159]
    buffer_load_dwordx4 v15, s[52:55], s14 offen offset:1024 lds
    s_add_u32 s14, s14, 57344
    s_waitcnt lgkmcnt(0)
    v_mfma_f32_32x32x16_bf16 v[96:111], v[32:35], v[40:43], v[96:111]
    s_waitcnt vmcnt(8)
    ds_read_b64_tr_b16 v[16:17], v12 offset:28672
    ds_read_b64_tr_b16 v[18:19], v12 offset:29184
    ds_read_b64_tr_b16 v[20:21], v13 offset:28672
    v_mfma_f32_32x32x16_bf16 v[112:127], v[32:35], v[44:47], v[112:127]
    ds_read_b64_tr_b16 v[22:23], v13 offset:29184
    ds_read_b128 v[24:27], v10 offset:24576
    ds_read_b128 v[28:31], v10 offset:28672
    v_mfma_f32_32x32x16_bf16 v[128:143], v[36:39], v[40:43], v[128:143]
    s_add_u32 m0, s13, 2048
    s_nop 0
    buffer_load_dwordx4 v14, s[52:55], s14 offen lds
    v_mfma_f32_32x32x16_bf16 v[144:159], v[36:39], v[44:47], v[144:159]
    buffer_load_dwordx4 v15, s[52:55], s14 offen offset:1024 lds
    s_add_u32 s14, s14, 57344
    s_waitcnt lgkmcnt(0)
    v_mfma_f32_32x32x16_bf16 v[96:111], v[16:19], v[24:27], v[96:111]
    s_waitcnt vmcnt(8)
    ds_read_b64_tr_b16 v[32:33], v12 offset:0
    ds_read_b64_tr_b16 v[34:35], v12 offset:512
    ds_read_b64_tr_b16 v[36:37], v13 offset:0
    v_mfma_f32_32x32x16_bf16 v[112:127], v[16:19], v[28:31], v[112:127]
    ds_read_b64_tr_b16 v[38:39], v13 offset:512
    ds_read_b128 v[40:43], v11 offset:24576
    ds_read_b128 v[44:47], v11 offset:28672
    v_mfma_f32_32x32x16_bf16 v[128:143], v[20:23], v[24:27], v[128:143]
    s_add_u32 s14, s58, 5
    s_and_b32 s14, s14, 7
    s_mul_i32 s14, s14, 229376
    s_add_u32 s14, s14, s15
    s_add_u32 m0, s13, 4096
    s_nop 0
    buffer_load_dwordx4 v14, s[52:55], s14 offen lds
    v_mfma_f32_32x32x16_bf16 v[144:159], v[20:23], v[28:31], v[144:159]
    buffer_load_dwordx4 v15, s[52:55], s14 offen offset:1024 lds
    s_add_u32 s14, s14, 57344
    s_waitcnt lgkmcnt(0)
    v_mfma_f32_32x32x16_bf16 v[96:111], v[32:35], v[40:43], v[96:111]
    s_waitcnt vmcnt(8)
    ds_read_b64_tr_b16 v[16:17], v12 offset:2048
    ds_read_b64_tr_b16 v[18:19], v12 offset:2560
    ds_read_b64_tr_b16 v[20:21], v13 offset:2048
    v_mfma_f32_32x32x16_bf16 v[112:127], v[32:35], v[44:47], v[112:127]
    ds_read_b64_tr_b16 v[22:23], v13 offset:2560
    ds_read_b128 v[24:27], v8 offset:32768
    ds_read_b128 v[28:31], v8 offset:36864
    v_mfma_f32_32x32x16_bf16 v[128:143], v[36:39], v[40:43], v[128:143]
    s_add_u32 m0, s62, 0
    s_nop 0
    buffer_load_dwordx4 v14, s[52:55], s14 offen lds
    v_mfma_f32_32x32x16_bf16 v[144:159], v[36:39], v[44:47], v[144:159]
    buffer_load_dwordx4 v15, s[52:55], s14 offen offset:1024 lds
    s_add_u32 s14, s14, 57344
    s_waitcnt lgkmcnt(0)
    v_mfma_f32_32x32x16_bf16 v[96:111], v[16:19], v[24:27], v[96:111]
    s_waitcnt vmcnt(8)
    ds_read_b64_tr_b16 v[32:33], v12 offset:4096
    ds_read_b64_tr_b16 v[34:35], v12 offset:4608
    ds_read_b64_tr_b16 v[36:37], v13 offset:4096
    v_mfma_f32_32x32x16_bf16 v[112:127], v[16:19], v[28:31], v[112:127]
    ds_read_b64_tr_b16 v[38:39], v13 offset:4608
    ds_read_b128 v[40:43], v9 offset:32768
    ds_read_b128 v[44:47], v9 offset:36864
    v_mfma_f32_32x32x16_bf16 v[128:143], v[20:23], v[24:27], v[128:143]
    s_add_u32 m0, s62, 2048
    s_nop 0
    buffer_load_dwordx4 v14, s[52:55], s14 offen lds
    v_mfma_f32_32x32x16_bf16 v[144:159], v[20:23], v[28:31], v[144:159]
    buffer_load_dwordx4 v15, s[52:55], s14 offen offset:1024 lds
    s_add_u32 s14, s14, 57344
    s_waitcnt lgkmcnt(0)
    v_mfma_f32_32x32x16_bf16 v[96:111], v[32:35], v[40:43], v[96:111]
    s_waitcnt vmcnt(8)
    ds_read_b64_tr_b16 v[16:17], v12 offset:24576
    ds_read_b64_tr_b16 v[18:19], v12 offset:25088
    ds_read_b64_tr_b16 v[20:21], v13 offset:24576
    v_mfma_f32_32x32x16_bf16 v[112:127], v[32:35], v[44:47], v[112:127]
    ds_read_b64_tr_b16 v[22:23], v13 offset:25088
    ds_read_b128 v[24:27], v10 offset:32768
    ds_read_b128 v[28:31], v10 offset:36864
    v_mfma_f32_32x32x16_bf16 v[128:143], v[36:39], v[40:43], v[128:143]
    s_add_u32 m0, s62, 4096
    s_nop 0
    buffer_load_dwordx4 v14, s[52:55], s14 offen lds
    v_mfma_f32_32x32x16_bf16 v[144:159], v[36:39], v[44:47], v[144:159]
    buffer_load_dwordx4 v15, s[52:55], s14 offen offset:1024 lds
    s_add_u32 s14, s14, 57344
    s_waitcnt lgkmcnt(0)
    v_mfma_f32_32x32x16_bf16 v[96:111], v[16:19], v[24:27], v[96:111]
    s_waitcnt vmcnt(8)
    ds_read_b64_tr_b16 v[32:33], v12 offset:26624
    ds_read_b64_tr_b16 v[34:35], v12 offset:27136
    ds_read_b64_tr_b16 v[36:37], v13 offset:26624
    v_mfma_f32_32x32x16_bf16 v[112:127], v[16:19], v[28:31], v[112:127]
    ds_read_b64_tr_b16 v[38:39], v13 offset:27136
    ds_read_b128 v[40:43], v11 offset:32768
    ds_read_b128 v[44:47], v11 offset:36864
    v_mfma_f32_32x32x16_bf16 v[128:143], v[20:23], v[24:27], v[128:143]
    s_add_u32 s14, s58, 6
    s_and_b32 s14, s14, 7
    s_mul_i32 s14, s14, 229376
    s_add_u32 s14, s14, s15
    s_add_u32 m0, s13, 0
    s_nop 0
    buffer_load_dwordx4 v14, s[52:55], s14 offen lds
    v_mfma_f32_32x32x16_bf16 v[144:159], v[20:23], v[28:31], v[144:159]
    buffer_load_dwordx4 v15, s[52:55], s14 offen offset:1024 lds
    s_add_u32 s14, s14, 57344
    s_waitcnt lgkmcnt(0)
    v_mfma_f32_32x32x16_bf16 v[96:111], v[32:35], v[40:43], v[96:111]
    s_waitcnt vmcnt(8)
    ds_read_b64_tr_b16 v[16:17], v12 offset:28672
    ds_read_b64_tr_b16 v[18:19], v12 offset:29184
    ds_read_b64_tr_b16 v[20:21], v13 offset:28672
    v_mfma_f32_32x32x16_bf16 v[112:127], v[32:35], v[44:47], v[112:127]
    ds_read_b64_tr_b16 v[22:23], v13 offset:29184
    ds_read_b128 v[24:27], v8 offset:40960
    ds_read_b128 v[28:31], v8 offset:45056
    v_mfma_f32_32x32x16_bf16 v[128:143], v[36:39], v[40:43], v[128:143]
    s_add_u32 m0, s13, 2048
    s_nop 0
    buffer_load_dwordx4 v14, s[52:55], s14 offen lds
    v_mfma_f32_32x32x16_bf16 v[144:159], v[36:39], v[44:47], v[144:159]
    buffer_load_dwordx4 v15, s[52:55], s14 offen offset:1024 lds
    s_add_u32 s14, s14, 57344
    s_waitcnt lgkmcnt(0)
    v_mfma_f32_32x32x16_bf16 v[96:111], v[16:19], v[24:27], v[96:111]
    s_waitcnt vmcnt(8)
    ds_read_b64_tr_b16 v[32:33], v12 offset:0
    ds_read_b64_tr_b16 v[34:35], v12 offset:512
    ds_read_b64_tr_b16 v[36:37], v13 offset:0
    v_mfma_f32_32x32x16_bf16 v[112:127], v[16:19], v[28:31], v[112:127]
    ds_read_b64_tr_b16 v[38:39], v13 offset:512
    ds_read_b128 v[40:43], v9 offset:40960
    ds_read_b128 v[44:47], v9 offset:45056
    v_mfma_f32_32x32x16_bf16 v[128:143], v[20:23], v[24:27], v[128:143]
    s_add_u32 m0, s13, 4096
    s_nop 0
    buffer_load_dwordx4 v14, s[52:55], s14 offen lds
    v_mfma_f32_32x32x16_bf16 v[144:159], v[20:23], v[28:31], v[144:159]
    buffer_load_dwordx4 v15, s[52:55], s14 offen offset:1024 lds
    s_add_u32 s14, s14, 57344
    s_waitcnt lgkmcnt(0)
    v_mfma_f32_32x32x16_bf16 v[96:111], v[32:35], v[40:43], v[96:111]
    s_waitcnt vmcnt(8)
    ds_read_b64_tr_b16 v[16:17], v12 offset:2048
    ds_read_b64_tr_b16 v[18:19], v12 offset:2560
    ds_read_b64_tr_b16 v[20:21], v13 offset:2048
    v_mfma_f32_32x32x16_bf16 v[112:127], v[32:35], v[44:47], v[112:127]
    ds_read_b64_tr_b16 v[22:23], v13 offset:2560
    ds_read_b128 v[24:27], v10 offset:40960
    ds_read_b128 v[28:31], v10 offset:45056
    v_mfma_f32_32x32x16_bf16 v[128:143], v[36:39], v[40:43], v[128:143]
    s_add_u32 m0, s62, 0
    s_nop 0
    buffer_load_dwordx4 v14, s[52:55], s14 offen lds
    v_mfma_f32_32x32x16_bf16 v[144:159], v[36:39], v[44:47], v[144:159]
    buffer_load_dwordx4 v15, s[52:55], s14 offen offset:1024 lds
    s_add_u32 s14, s14, 57344
    s_waitcnt lgkmcnt(0)
    v_mfma_f32_32x32x16_bf16 v[96:111], v[16:19], v[24:27], v[96:111]
    s_waitcnt vmcnt(8)
    ds_read_b64_tr_b16 v[32:33], v12 offset:4096
    ds_read_b64_tr_b16 v[34:35], v12 offset:4608
    ds_read_b64_tr_b16 v[36:37], v13 offset:4096
    v_mfma_f32_32x32x16_bf16 v[112:127], v[16:19], v[28:31], v[112:127]
    ds_read_b64_tr_b16 v[38:39], v13 offset:4608
    ds_read_b128 v[40:43], v11 offset:40960
    ds_read_b128 v[44:47], v11 offset:45056
    v_mfma_f32_32x32x16_bf16 v[128:143], v[20:23], v[24:27], v[128:143]
    s_add_u32 s14, s58, 7
    s_and_b32 s14, s14, 7
    s_mul_i32 s14, s14, 229376
    s_add_u32 s14, s14, s15
    s_add_u32 m0, s62, 2048
    s_nop 0
    buffer_load_dwordx4 v14, s[52:55], s14 offen lds
    v_mfma_f32_32x32x16_bf16 v[144:159], v[20:23], v[28:31], v[144:159]
    buffer_load_dwordx4 v15, s[52:55], s14 offen offset:1024 lds
    s_add_u32 s14, s14, 57344
    s_waitcnt lgkmcnt(0)
    v_mfma_f32_32x32x16_bf16 v[96:111], v[32:35], v[40:43], v[96:111]
    s_waitcnt vmcnt(8)
    ds_read_b64_tr_b16 v[16:17], v12 offset:24576
    ds_read_b64_tr_b16 v[18:19], v12 offset:25088
    ds_read_b64_tr_b16 v[20:21], v13 offset:24576
    v_mfma_f32_32x32x16_bf16 v[112:127], v[32:35], v[44:47], v[112:127]
    ds_read_b64_tr_b16 v[22:23], v13 offset:25088
    ds_read_b128 v[24:27], v8 offset:49152
    ds_read_b128 v[28:31], v8 offset:53248
    v_mfma_f32_32x32x16_bf16 v[128:143], v[36:39], v[40:43], v[128:143]
    s_add_u32 m0, s62, 4096
    s_nop 0
    buffer_load_dwordx4 v14, s[52:55], s14 offen lds
    v_mfma_f32_32x32x16_bf16 v[144:159], v[36:39], v[44:47], v[144:159]
    buffer_load_dwordx4 v15, s[52:55], s14 offen offset:1024 lds
    s_add_u32 s14, s14, 57344
    s_waitcnt lgkmcnt(0)
    v_mfma_f32_32x32x16_bf16 v[96:111], v[16:19], v[24:27], v[96:111]
    s_waitcnt vmcnt(8)
    ds_read_b64_tr_b16 v[32:33], v12 offset:26624
    ds_read_b64_tr_b16 v[34:35], v12 offset:27136
    ds_read_b64_tr_b16 v[36:37], v13 offset:26624
    v_mfma_f32_32x32x16_bf16 v[112:127], v[16:19], v[28:31], v[112:127]
    ds_read_b64_tr_b16 v[38:39], v13 offset:27136
    ds_read_b128 v[40:43], v9 offset:49152
    ds_read_b128 v[44:47], v9 offset:53248
    v_mfma_f32_32x32x16_bf16 v[128:143], v[20:23], v[24:27], v[128:143]
    s_add_u32 m0, s13, 0
    s_nop 0
    buffer_load_dwordx4 v14, s[52:55], s14 offen lds
    v_mfma_f32_32x32x16_bf16 v[144:159], v[20:23], v[28:31], v[144:159]
    buffer_load_dwordx4 v15, s[52:55], s14 offen offset:1024 lds
    s_add_u32 s14, s14, 57344
    s_waitcnt lgkmcnt(0)
    v_mfma_f32_32x32x16_bf16 v[96:111], v[32:35], v[40:43], v[96:111]
    s_waitcnt vmcnt(8)
    ds_read_b64_tr_b16 v[16:17], v12 offset:28672
    ds_read_b64_tr_b16 v[18:19], v12 offset:29184
    ds_read_b64_tr_b16 v[20:21], v13 offset:28672
    v_mfma_f32_32x32x16_bf16 v[112:127], v[32:35], v[44:47], v[112:127]
    ds_read_b64_tr_b16 v[22:23], v13 offset:29184
    ds_read_b128 v[24:27], v10 offset:49152
    ds_read_b128 v[28:31], v10 offset:53248
    v_mfma_f32_32x32x16_bf16 v[128:143], v[36:39], v[40:43], v[128:143]
    s_add_u32 m0, s13, 2048
    s_nop 0
    buffer_load_dwordx4 v14, s[52:55], s14 offen lds
    v_mfma_f32_32x32x16_bf16 v[144:159], v[36:39], v[44:47], v[144:159]
    buffer_load_dwordx4 v15, s[52:55], s14 offen offset:1024 lds
    s_add_u32 s14, s14, 57344
    s_waitcnt lgkmcnt(0)
    v_mfma_f32_32x32x16_bf16 v[96:111], v[16:19], v[24:27], v[96:111]
    s_waitcnt vmcnt(8)
    ds_read_b64_tr_b16 v[32:33], v12 offset:0
    ds_read_b64_tr_b16 v[34:35], v12 offset:512
    ds_read_b64_tr_b16 v[36:37], v13 offset:0
    v_mfma_f32_32x32x16_bf16 v[112:127], v[16:19], v[28:31], v[112:127]
    ds_read_b64_tr_b16 v[38:39], v13 offset:512
    ds_read_b128 v[40:43], v11 offset:49152
    ds_read_b128 v[44:47], v11 offset:53248
    v_mfma_f32_32x32x16_bf16 v[128:143], v[20:23], v[24:27], v[128:143]
    v_mfma_f32_32x32x16_bf16 v[144:159], v[20:23], v[28:31], v[144:159]
    s_waitcnt lgkmcnt(0)
    v_mfma_f32_32x32x16_bf16 v[96:111], v[32:35], v[40:43], v[96:111]
    s_waitcnt vmcnt(6)
    s_lshl_b32 s9, s59, 16
    s_sub_u32 s9, 57344, s9
    v_add_u32 v8, s9, v8
    v_add_u32 v9, s9, v9
    v_add_u32 v10, s9, v10
    v_add_u32 v11, s9, v11
    ds_read_b64_tr_b16 v[16:17], v12 offset:2048
    ds_read_b64_tr_b16 v[18:19], v12 offset:2560
    ds_read_b64_tr_b16 v[20:21], v13 offset:2048
    v_mfma_f32_32x32x16_bf16 v[112:127], v[32:35], v[44:47], v[112:127]
    ds_read_b64_tr_b16 v[22:23], v13 offset:2560
    ds_read_b128 v[24:27], v8 offset:0
    ds_read_b128 v[28:31], v8 offset:4096
    v_mfma_f32_32x32x16_bf16 v[128:143], v[36:39], v[40:43], v[128:143]
    v_mfma_f32_32x32x16_bf16 v[144:159], v[36:39], v[44:47], v[144:159]
    s_waitcnt lgkmcnt(0)
    v_mfma_f32_32x32x16_bf16 v[96:111], v[16:19], v[24:27], v[96:111]
    s_waitcnt vmcnt(4)
    ds_read_b64_tr_b16 v[32:33], v12 offset:4096
    ds_read_b64_tr_b16 v[34:35], v12 offset:4608
    ds_read_b64_tr_b16 v[36:37], v13 offset:4096
    v_mfma_f32_32x32x16_bf16 v[112:127], v[16:19], v[28:31], v[112:127]
    ds_read_b64_tr_b16 v[38:39], v13 offset:4608
    ds_read_b128 v[40:43], v9 offset:0
    ds_read_b128 v[44:47], v9 offset:4096
    v_mfma_f32_32x32x16_bf16 v[128:143], v[20:23], v[24:27], v[128:143]
    v_mfma_f32_32x32x16_bf16 v[144:159], v[20:23], v[28:31], v[144:159]
    s_waitcnt lgkmcnt(0)
    v_mfma_f32_32x32x16_bf16 v[96:111], v[32:35], v[40:43], v[96:111]
    s_waitcnt vmcnt(2)
    ds_read_b64_tr_b16 v[16:17], v12 offset:24576
    ds_read_b64_tr_b16 v[18:19], v12 offset:25088
    ds_read_b64_tr_b16 v[20:21], v13 offset:24576
    v_mfma_f32_32x32x16_bf16 v[112:127], v[32:35], v[44:47], v[112:127]
    ds_read_b64_tr_b16 v[22:23], v13 offset:25088
    ds_read_b128 v[24:27], v10 offset:0
    ds_read_b128 v[28:31], v10 offset:4096
    v_mfma_f32_32x32x16_bf16 v[128:143], v[36:39], v[40:43], v[128:143]
    v_mfma_f32_32x32x16_bf16 v[144:159], v[36:39], v[44:47], v[144:159]
    s_waitcnt lgkmcnt(0)
    v_mfma_f32_32x32x16_bf16 v[96:111], v[16:19], v[24:27], v[96:111]
    s_waitcnt vmcnt(0)
    ds_read_b64_tr_b16 v[32:33], v12 offset:26624
    ds_read_b64_tr_b16 v[34:35], v12 offset:27136
    ds_read_b64_tr_b16 v[36:37], v13 offset:26624
    v_mfma_f32_32x32x16_bf16 v[112:127], v[16:19], v[28:31], v[112:127]
    ds_read_b64_tr_b16 v[38:39], v13 offset:27136
    ds_read_b128 v[40:43], v11 offset:0
    ds_read_b128 v[44:47], v11 offset:4096
    v_mfma_f32_32x32x16_bf16 v[128:143], v[20:23], v[24:27], v[128:143]
    v_mfma_f32_32x32x16_bf16 v[144:159], v[20:23], v[28:31], v[144:159]
    s_waitcnt lgkmcnt(0)
    v_mfma_f32_32x32x16_bf16 v[96:111], v[32:35], v[40:43], v[96:111]
    v_mfma_f32_32x32x16_bf16 v[112:127], v[32:35], v[44:47], v[112:127]
    v_mfma_f32_32x32x16_bf16 v[128:143], v[36:39], v[40:43], v[128:143]
    v_mfma_f32_32x32x16_bf16 v[144:159], v[36:39], v[44:47], v[144:159]
L_bi1:
    s_setprio 3
    s_waitcnt lgkmcnt(0)
    s_mov_b64 exec, 1
    ds_add_u32 v160, v161 offset:16
    s_mov_b64 exec, -1
    v_mov_b32 v32, 0xc0135761
    v_mov_b32 v34, 0xbdd2d3e8
    v_mov_b32 v36, 1.0
    v_mov_b32 v33, 0xc0135761
    v_mov_b32 v35, 0xbdd2d3e8
    v_mov_b32 v37, 1.0
    s_mul_i32 s10, s4, 229376
    s_lshl_b32 s9, s63, 11
    s_add_u32 s10, s10, s9
    s_add_u32 s10, s10, 16777216
    s_add_u32 s11, s10, 114688
    s_lshl_b32 s62, s7, 12
    s_lshl_b32 s9, s8, 13
    s_add_u32 s62, s62, s9
    s_lshl_b32 s63, s7, 21
    s_lshl_b32 s9, s66, 16
    s_add_u32 s63, s63, s9
    s_lshl_b32 s9, s8, 12
    s_add_u32 s63, s63, s9
    s_add_u32 s63, s63, 2097152
    s_cmp_eq_u32 s61, 3
    s_cbranch_scc1 L_bi2
    v_pk_mul_f32 v[16:17], v[96:97], v[96:97]
    v_pk_mul_f32 v[18:19], v[98:99], v[98:99]
    v_pk_mul_f32 v[20:21], v[100:101], v[100:101]
    v_pk_mul_f32 v[22:23], v[102:103], v[102:103]
    v_pk_mul_f32 v[24:25], v[104:105], v[104:105]
    v_pk_mul_f32 v[26:27], v[106:107], v[106:107]
    v_pk_mul_f32 v[28:29], v[108:109], v[108:109]
    v_pk_mul_f32 v[30:31], v[110:111], v[110:111]
    v_pk_fma_f32 v[16:17], v[16:17], v[34:35], v[32:33]
    v_pk_fma_f32 v[18:19], v[18:19], v[34:35], v[32:33]
    v_pk_fma_f32 v[20:21], v[20:21], v[34:35], v[32:33]
    v_pk_fma_f32 v[22:23], v[22:23], v[34:35], v[32:33]
    v_pk_fma_f32 v[24:25], v[24:25], v[34:35], v[32:33]
    v_pk_fma_f32 v[26:27], v[26:27], v[34:35], v[32:33]
    v_pk_fma_f32 v[28:29], v[28:29], v[34:35], v[32:33]
    v_pk_fma_f32 v[30:31], v[30:31], v[34:35], v[32:33]
    v_pk_mul_f32 v[16:17], v[16:17], v[96:97]
    v_pk_mul_f32 v[18:19], v[18:19], v[98:99]
    v_pk_mul_f32 v[20:21], v[20:21], v[100:101]
    v_pk_mul_f32 v[22:23], v[22:23], v[102:103]
    v_pk_mul_f32 v[24:25], v[24:25], v[104:105]
    v_pk_mul_f32 v[26:27], v[26:27], v[106:107]
    v_pk_mul_f32 v[28:29], v[28:29], v[108:109]
    v_pk_mul_f32 v[30:31], v[30:31], v[110:111]
    v_exp_f32 v16, v16
    v_exp_f32 v17, v17
    v_exp_f32 v18, v18
    v_exp_f32 v19, v19
    v_exp_f32 v20, v20
    v_exp_f32 v21, v21
    v_exp_f32 v22, v22
    v_exp_f32 v23, v23
    v_exp_f32 v24, v24
    v_exp_f32 v25, v25
    v_exp_f32 v26, v26
    v_exp_f32 v27, v27
    v_exp_f32 v28, v28
    v_exp_f32 v29, v29
    v_exp_f32 v30, v30
    v_exp_f32 v31, v31
    v_pk_add_f32 v[16:17], v[16:17], v[36:37]
    v_pk_add_f32 v[18:19], v[18:19], v[36:37]
    v_pk_add_f32 v[20:21], v[20:21], v[36:37]
    v_pk_add_f32 v[22:23], v[22:23], v[36:37]
    v_pk_add_f32 v[24:25], v[24:25], v[36:37]
    v_pk_add_f32 v[26:27], v[26:27], v[36:37]
    v_pk_add_f32 v[28:29], v[28:29], v[36:37]
    v_pk_add_f32 v[30:31], v[30:31], v[36:37]
    v_rcp_f32 v16, v16
    v_rcp_f32 v17, v17
    v_rcp_f32 v18, v18
    v_rcp_f32 v19, v19
    v_rcp_f32 v20, v20
    v_rcp_f32 v21, v21
    v_rcp_f32 v22, v22
    v_rcp_f32 v23, v23
    v_rcp_f32 v24, v24
    v_rcp_f32 v25, v25
    v_rcp_f32 v26, v26
    v_rcp_f32 v27, v27
    v_rcp_f32 v28, v28
    v_rcp_f32 v29, v29
    v_rcp_f32 v30, v30
    v_rcp_f32 v31, v31
    v_pk_mul_f32 v[16:17], v[16:17], v[96:97]
    v_pk_mul_f32 v[18:19], v[18:19], v[98:99]
    v_pk_mul_f32 v[20:21], v[20:21], v[100:101]
    v_pk_mul_f32 v[22:23], v[22:23], v[102:103]
    v_pk_mul_f32 v[24:25], v[24:25], v[104:105]
    v_pk_mul_f32 v[26:27], v[26:27], v[106:107]
    v_pk_mul_f32 v[28:29], v[28:29], v[108:109]
    v_pk_mul_f32 v[30:31], v[30:31], v[110:111]
    v_cvt_pk_bf16_f32 v40, v16, v17
    v_cvt_pk_bf16_f32 v41, v18, v19
    v_cvt_pk_bf16_f32 v42, v20, v21
    v_cvt_pk_bf16_f32 v43, v22, v23
    v_cvt_pk_bf16_f32 v44, v24, v25
    v_cvt_pk_bf16_f32 v45, v26, v27
    v_cvt_pk_bf16_f32 v46, v28, v29
    v_cvt_pk_bf16_f32 v47, v30, v31
    buffer_store_dwordx4 v[40:43], v5, s[48:51], s10 offen offset:0 sc1
    buffer_store_dwordx4 v[44:47], v5, s[48:51], s10 offen offset:1024 sc1
    v_pk_mul_f32 v[16:17], v[112:113], v[112:113]
    v_pk_mul_f32 v[18:19], v[114:115], v[114:115]
    v_pk_mul_f32 v[20:21], v[116:117], v[116:117]
    v_pk_mul_f32 v[22:23], v[118:119], v[118:119]
    v_pk_mul_f32 v[24:25], v[120:121], v[120:121]
    v_pk_mul_f32 v[26:27], v[122:123], v[122:123]
    v_pk_mul_f32 v[28:29], v[124:125], v[124:125]
    v_pk_mul_f32 v[30:31], v[126:127], v[126:127]
    v_pk_fma_f32 v[16:17], v[16:17], v[34:35], v[32:33]
    v_pk_fma_f32 v[18:19], v[18:19], v[34:35], v[32:33]
    v_pk_fma_f32 v[20:21], v[20:21], v[34:35], v[32:33]
    v_pk_fma_f32 v[22:23], v[22:23], v[34:35], v[32:33]
    v_pk_fma_f32 v[24:25], v[24:25], v[34:35], v[32:33]
    v_pk_fma_f32 v[26:27], v[26:27], v[34:35], v[32:33]
    v_pk_fma_f32 v[28:29], v[28:29], v[34:35], v[32:33]
    v_pk_fma_f32 v[30:31], v[30:31], v[34:35], v[32:33]
    v_pk_mul_f32 v[16:17], v[16:17], v[112:113]
    v_pk_mul_f32 v[18:19], v[18:19], v[114:115]
    v_pk_mul_f32 v[20:21], v[20:21], v[116:117]
    v_pk_mul_f32 v[22:23], v[22:23], v[118:119]
    v_pk_mul_f32 v[24:25], v[24:25], v[120:121]
    v_pk_mul_f32 v[26:27], v[26:27], v[122:123]
    v_pk_mul_f32 v[28:29], v[28:29], v[124:125]
    v_pk_mul_f32 v[30:31], v[30:31], v[126:127]
    v_exp_f32 v16, v16
    v_exp_f32 v17, v17
    v_exp_f32 v18, v18
    v_exp_f32 v19, v19
    v_exp_f32 v20, v20
    v_exp_f32 v21, v21
    v_exp_f32 v22, v22
    v_exp_f32 v23, v23
    v_exp_f32 v24, v24
    v_exp_f32 v25, v25
    v_exp_f32 v26, v26
    v_exp_f32 v27, v27
    v_exp_f32 v28, v28
    v_exp_f32 v29, v29
    v_exp_f32 v30, v30
    v_exp_f32 v31, v31
    v_pk_add_f32 v[16:17], v[16:17], v[36:37]
    v_pk_add_f32 v[18:19], v[18:19], v[36:37]
    v_pk_add_f32 v[20:21], v[20:21], v[36:37]
    v_pk_add_f32 v[22:23], v[22:23], v[36:37]
    v_pk_add_f32 v[24:25], v[24:25], v[36:37]
    v_pk_add_f32 v[26:27], v[26:27], v[36:37]
    v_pk_add_f32 v[28:29], v[28:29], v[36:37]
    v_pk_add_f32 v[30:31], v[30:31], v[36:37]
    v_rcp_f32 v16, v16
    v_rcp_f32 v17, v17
    v_rcp_f32 v18, v18
    v_rcp_f32 v19, v19
    v_rcp_f32 v20, v20
    v_rcp_f32 v21, v21
    v_rcp_f32 v22, v22
    v_rcp_f32 v23, v23
    v_rcp_f32 v24, v24
    v_rcp_f32 v25, v25
    v_rcp_f32 v26, v26
    v_rcp_f32 v27, v27
    v_rcp_f32 v28, v28
    v_rcp_f32 v29, v29
    v_rcp_f32 v30, v30
    v_rcp_f32 v31, v31
    v_pk_mul_f32 v[16:17], v[16:17], v[112:113]
    v_pk_mul_f32 v[18:19], v[18:19], v[114:115]
    v_pk_mul_f32 v[20:21], v[20:21], v[116:117]
    v_pk_mul_f32 v[22:23], v[22:23], v[118:119]
    v_pk_mul_f32 v[24:25], v[24:25], v[120:121]
    v_pk_mul_f32 v[26:27], v[26:27], v[122:123]
    v_pk_mul_f32 v[28:29], v[28:29], v[124:125]
    v_pk_mul_f32 v[30:31], v[30:31], v[126:127]
    v_cvt_pk_bf16_f32 v48, v16, v17
    v_cvt_pk_bf16_f32 v49, v18, v19
    v_cvt_pk_bf16_f32 v50, v20, v21
    v_cvt_pk_bf16_f32 v51, v22, v23
    v_cvt_pk_bf16_f32 v52, v24, v25
    v_cvt_pk_bf16_f32 v53, v26, v27
    v_cvt_pk_bf16_f32 v54, v28, v29
    v_cvt_pk_bf16_f32 v55, v30, v31
    buffer_store_dwordx4 v[48:51], v5, s[48:51], s11 offen offset:0 sc1
    buffer_store_dwordx4 v[52:55], v5, s[48:51], s11 offen offset:1024 sc1
L_bi2:
    s_mov_b32 s64, 0
    s_branch L_bs1_1
L_bs1:
    s_sleep 2
L_bs1_1:
    ds_read_b32 v7, v160 offset:16
    s_add_u32 s64, s64, 1
    s_waitcnt lgkmcnt(0)
    v_readfirstlane_b32 s9, v7
    s_lshr_b32 s65, s64, 18
    s_add_u32 s9, s9, s65
    s_cmp_lt_u32 s9, 4
    s_cbranch_scc1 L_bs1
    s_mov_b32 s64, 0
    s_branch L_bgo_1
L_bgo:
    s_sleep 2
L_bgo_1:
    ds_read_b32 v7, v160 offset:0
    s_add_u32 s64, s64, 1
    s_waitcnt lgkmcnt(0)
    v_readfirstlane_b32 s9, v7
    s_lshr_b32 s65, s64, 18
    s_add_u32 s9, s9, s65
    s_cmp_lt_u32 s9, 8
    s_cbranch_scc1 L_bgo
    s_add_u32 s60, s62, 106496
    s_and_b32 m0, s60, 0x1ffff
    s_add_u32 s60, s63, 20480
    buffer_load_dwordx4 v5, s[48:51], s60 offen offset:0 sc1 lds
    buffer_load_dwordx4 v5, s[48:51], s60 offen offset:1024 sc1 lds
    buffer_load_dwordx4 v5, s[48:51], s60 offen offset:2048 sc1 lds
    buffer_load_dwordx4 v5, s[48:51], s60 offen offset:3072 sc1 lds
    s_add_u32 s60, s62, 122880
    s_and_b32 m0, s60, 0x1ffff
    s_add_u32 s60, s63, 28672
    buffer_load_dwordx4 v5, s[48:51], s60 offen offset:0 sc1 lds
    buffer_load_dwordx4 v5, s[48:51], s60 offen offset:1024 sc1 lds
    buffer_load_dwordx4 v5, s[48:51], s60 offen offset:2048 sc1 lds
    buffer_load_dwordx4 v5, s[48:51], s60 offen offset:3072 sc1 lds
    s_cmp_eq_u32 s61, 3
    s_cbranch_scc1 L_bi3
    v_pk_mul_f32 v[16:17], v[128:129], v[128:129]
    v_pk_mul_f32 v[18:19], v[130:131], v[130:131]
    v_pk_mul_f32 v[20:21], v[132:133], v[132:133]
    v_pk_mul_f32 v[22:23], v[134:135], v[134:135]
    v_pk_mul_f32 v[24:25], v[136:137], v[136:137]
    v_pk_mul_f32 v[26:27], v[138:139], v[138:139]
    v_pk_mul_f32 v[28:29], v[140:141], v[140:141]
    v_pk_mul_f32 v[30:31], v[142:143], v[142:143]
    v_pk_fma_f32 v[16:17], v[16:17], v[34:35], v[32:33]
    v_pk_fma_f32 v[18:19], v[18:19], v[34:35], v[32:33]
    v_pk_fma_f32 v[20:21], v[20:21], v[34:35], v[32:33]
    v_pk_fma_f32 v[22:23], v[22:23], v[34:35], v[32:33]
    v_pk_fma_f32 v[24:25], v[24:25], v[34:35], v[32:33]
    v_pk_fma_f32 v[26:27], v[26:27], v[34:35], v[32:33]
    v_pk_fma_f32 v[28:29], v[28:29], v[34:35], v[32:33]
    v_pk_fma_f32 v[30:31], v[30:31], v[34:35], v[32:33]
    v_pk_mul_f32 v[16:17], v[16:17], v[128:129]
    v_pk_mul_f32 v[18:19], v[18:19], v[130:131]
    v_pk_mul_f32 v[20:21], v[20:21], v[132:133]
    v_pk_mul_f32 v[22:23], v[22:23], v[134:135]
    v_pk_mul_f32 v[24:25], v[24:25], v[136:137]
    v_pk_mul_f32 v[26:27], v[26:27], v[138:139]
    v_pk_mul_f32 v[28:29], v[28:29], v[140:141]
    v_pk_mul_f32 v[30:31], v[30:31], v[142:143]
    v_exp_f32 v16, v16
    v_exp_f32 v17, v17
    v_exp_f32 v18, v18
    v_exp_f32 v19, v19
    v_exp_f32 v20, v20
    v_exp_f32 v21, v21
    v_exp_f32 v22, v22
    v_exp_f32 v23, v23
    v_exp_f32 v24, v24
    v_exp_f32 v25, v25
    v_exp_f32 v26, v26
    v_exp_f32 v27, v27
    v_exp_f32 v28, v28
    v_exp_f32 v29, v29
    v_exp_f32 v30, v30
    v_exp_f32 v31, v31
    v_pk_add_f32 v[16:17], v[16:17], v[36:37]
    v_pk_add_f32 v[18:19], v[18:19], v[36:37]
    v_pk_add_f32 v[20:21], v[20:21], v[36:37]
    v_pk_add_f32 v[22:23], v[22:23], v[36:37]
    v_pk_add_f32 v[24:25], v[24:25], v[36:37]
    v_pk_add_f32 v[26:27], v[26:27], v[36:37]
    v_pk_add_f32 v[28:29], v[28:29], v[36:37]
    v_pk_add_f32 v[30:31], v[30:31], v[36:37]
    v_rcp_f32 v16, v16
    v_rcp_f32 v17, v17
    v_rcp_f32 v18, v18
    v_rcp_f32 v19, v19
    v_rcp_f32 v20, v20
    v_rcp_f32 v21, v21
    v_rcp_f32 v22, v22
    v_rcp_f32 v23, v23
    v_rcp_f32 v24, v24
    v_rcp_f32 v25, v25
    v_rcp_f32 v26, v26
    v_rcp_f32 v27, v27
    v_rcp_f32 v28, v28
    v_rcp_f32 v29, v29
    v_rcp_f32 v30, v30
    v_rcp_f32 v31, v31
    v_pk_mul_f32 v[16:17], v[16:17], v[128:129]
    v_pk_mul_f32 v[18:19], v[18:19], v[130:131]
    v_pk_mul_f32 v[20:21], v[20:21], v[132:133]
    v_pk_mul_f32 v[22:23], v[22:23], v[134:135]
    v_pk_mul_f32 v[24:25], v[24:25], v[136:137]
    v_pk_mul_f32 v[26:27], v[26:27], v[138:139]
    v_pk_mul_f32 v[28:29], v[28:29], v[140:141]
    v_pk_mul_f32 v[30:31], v[30:31], v[142:143]
    v_cvt_pk_bf16_f32 v56, v16, v17
    v_cvt_pk_bf16_f32 v57, v18, v19
    v_cvt_pk_bf16_f32 v58, v20, v21
    v_cvt_pk_bf16_f32 v59, v22, v23
    v_cvt_pk_bf16_f32 v60, v24, v25
    v_cvt_pk_bf16_f32 v61, v26, v27
    v_cvt_pk_bf16_f32 v62, v28, v29
    v_cvt_pk_bf16_f32 v63, v30, v31
    buffer_store_dwordx4 v[56:59], v5, s[48:51], s10 offen offset:2048 sc1
    buffer_store_dwordx4 v[60:63], v5, s[48:51], s10 offen offset:3072 sc1
    v_pk_mul_f32 v[16:17], v[144:145], v[144:145]
    v_pk_mul_f32 v[18:19], v[146:147], v[146:147]
    v_pk_mul_f32 v[20:21], v[148:149], v[148:149]
    v_pk_mul_f32 v[22:23], v[150:151], v[150:151]
    v_pk_mul_f32 v[24:25], v[152:153], v[152:153]
    v_pk_mul_f32 v[26:27], v[154:155], v[154:155]
    v_pk_mul_f32 v[28:29], v[156:157], v[156:157]
    v_pk_mul_f32 v[30:31], v[158:159], v[158:159]
    v_pk_fma_f32 v[16:17], v[16:17], v[34:35], v[32:33]
    v_pk_fma_f32 v[18:19], v[18:19], v[34:35], v[32:33]
    v_pk_fma_f32 v[20:21], v[20:21], v[34:35], v[32:33]
    v_pk_fma_f32 v[22:23], v[22:23], v[34:35], v[32:33]
    v_pk_fma_f32 v[24:25], v[24:25], v[34:35], v[32:33]
    v_pk_fma_f32 v[26:27], v[26:27], v[34:35], v[32:33]
    v_pk_fma_f32 v[28:29], v[28:29], v[34:35], v[32:33]
    v_pk_fma_f32 v[30:31], v[30:31], v[34:35], v[32:33]
    v_pk_mul_f32 v[16:17], v[16:17], v[144:145]
    v_pk_mul_f32 v[18:19], v[18:19], v[146:147]
    v_pk_mul_f32 v[20:21], v[20:21], v[148:149]
    v_pk_mul_f32 v[22:23], v[22:23], v[150:151]
    v_pk_mul_f32 v[24:25], v[24:25], v[152:153]
    v_pk_mul_f32 v[26:27], v[26:27], v[154:155]
    v_pk_mul_f32 v[28:29], v[28:29], v[156:157]
    v_pk_mul_f32 v[30:31], v[30:31], v[158:159]
    v_exp_f32 v16, v16
    v_exp_f32 v17, v17
    v_exp_f32 v18, v18
    v_exp_f32 v19, v19
    v_exp_f32 v20, v20
    v_exp_f32 v21, v21
    v_exp_f32 v22, v22
    v_exp_f32 v23, v23
    v_exp_f32 v24, v24
    v_exp_f32 v25, v25
    v_exp_f32 v26, v26
    v_exp_f32 v27, v27
    v_exp_f32 v28, v28
    v_exp_f32 v29, v29
    v_exp_f32 v30, v30
    v_exp_f32 v31, v31
    v_pk_add_f32 v[16:17], v[16:17], v[36:37]
    v_pk_add_f32 v[18:19], v[18:19], v[36:37]
    v_pk_add_f32 v[20:21], v[20:21], v[36:37]
    v_pk_add_f32 v[22:23], v[22:23], v[36:37]
    v_pk_add_f32 v[24:25], v[24:25], v[36:37]
    v_pk_add_f32 v[26:27], v[26:27], v[36:37]
    v_pk_add_f32 v[28:29], v[28:29], v[36:37]
    v_pk_add_f32 v[30:31], v[30:31], v[36:37]
    v_rcp_f32 v16, v16
    v_rcp_f32 v17, v17
    v_rcp_f32 v18, v18
    v_rcp_f32 v19, v19
    v_rcp_f32 v20, v20
    v_rcp_f32 v21, v21
    v_rcp_f32 v22, v22
    v_rcp_f32 v23, v23
    v_rcp_f32 v24, v24
    v_rcp_f32 v25, v25
    v_rcp_f32 v26, v26
    v_rcp_f32 v27, v27
    v_rcp_f32 v28, v28
    v_rcp_f32 v29, v29
    v_rcp_f32 v30, v30
    v_rcp_f32 v31, v31
    v_pk_mul_f32 v[16:17], v[16:17], v[144:145]
    v_pk_mul_f32 v[18:19], v[18:19], v[146:147]
    v_pk_mul_f32 v[20:21], v[20:21], v[148:149]
    v_pk_mul_f32 v[22:23], v[22:23], v[150:151]
    v_pk_mul_f32 v[24:25], v[24:25], v[152:153]
    v_pk_mul_f32 v[26:27], v[26:27], v[154:155]
    v_pk_mul_f32 v[28:29], v[28:29], v[156:157]
    v_pk_mul_f32 v[30:31], v[30:31], v[158:159]
    v_cvt_pk_bf16_f32 v64, v16, v17
    v_cvt_pk_bf16_f32 v65, v18, v19
    v_cvt_pk_bf16_f32 v66, v20, v21
    v_cvt_pk_bf16_f32 v67, v22, v23
    v_cvt_pk_bf16_f32 v68, v24, v25
    v_cvt_pk_bf16_f32 v69, v26, v27
    v_cvt_pk_bf16_f32 v70, v28, v29
    v_cvt_pk_bf16_f32 v71, v30, v31
    buffer_store_dwordx4 v[64:67], v5, s[48:51], s11 offen offset:2048 sc1
    buffer_store_dwordx4 v[68:71], v5, s[48:51], s11 offen offset:3072 sc1
    s_waitcnt vmcnt(4)
    s_mov_b64 exec, 1
    ds_add_u32 v160, v161 offset:8
    s_mov_b64 exec, -1
    s_branch L_bi4
L_bi3:
    s_waitcnt vmcnt(0)
    s_mov_b64 exec, 1
    ds_add_u32 v160, v161 offset:8
    s_mov_b64 exec, -1
L_bi4:
    s_mov_b32 s40, s28
    s_and_b32 s41, s29, 0xffff
    s_mov_b32 s42, 1835008
    s_mov_b32 s43, 0x00020000
    s_mov_b32 s44, s20
    s_and_b32 s45, s21, 0xffff
    s_mov_b32 s46, 524288
    s_mov_b32 s47, 0x00020000
    s_mov_b32 s52, s30
    s_and_b32 s53, s31, 0xffff
    s_mov_b32 s54, 1024
    s_mov_b32 s55, 0x00020000
    s_mov_b32 s56, s34
    s_and_b32 s57, s35, 0xffff
    s_mov_b32 s58, 2097152
    s_mov_b32 s59, 0x00020000
    v_lshrrev_b32 v6, 3, v1
    v_lshlrev_b32 v8, 10, v6
    v_and_b32 v6, 7, v1
    v_bfe_u32 v7, v1, 4, 1
    v_lshlrev_b32 v7, 2, v7
    v_xor_b32 v7, v6, v7
    v_lshl_add_u32 v8, v7, 4, v8
    v_add_u32 v11, 7168, v8
    s_mul_i32 s13, s12, 6144
    s_add_u32 s13, s13, 131072
    v_and_b32 v7, 1, v1
    v_lshlrev_b32 v12, 5, v7
    v_bfe_u32 v7, v1, 4, 1
    v_lshl_add_u32 v12, v7, 4, v12
    v_bfe_u32 v7, v1, 1, 1
    v_lshl_add_u32 v12, v7, 3, v12
    v_add_u32 v12, s13, v12
    v_bfe_u32 v13, v1, 2, 2
    v_lshl_add_u32 v6, v4, 2, v13
    v_lshl_add_u32 v16, v6, 7, v12
    v_lshl_add_u32 v12, v6, 6, v12
    v_lshrrev_b32 v13, 1, v13
    v_xor_b32 v13, s8, v13
    v_lshl_add_u32 v9, v13, 6, v16
    v_xor_b32 v13, 1, v13
    v_lshl_add_u32 v10, v13, 6, v16
    s_mul_i32 s14, s12, 458752
    s_lshl_b32 s9, s5, 7
    s_add_u32 s14, s14, s9
    s_lshl_b32 s15, s8, 6
    s_add_u32 s15, s15, s9
    s_lshl_b32 s9, s4, 11
    s_add_u32 s9, s9, 10747904
    s_lshl_b32 s10, s5, 5
    s_lshl_b32 s11, s12, 3
    s_add_u32 s10, s10, s11
    s_add_u32 s10, s10, s9
    v_lshlrev_b32 v6, 8, v1
    v_mov_b32 v164, s68
    v_mov_b32 v165, s69
    s_waitcnt vmcnt(0)
    s_mov_b64 exec, 0xff
    buffer_store_dwordx2 v[164:165], v6, s[48:51], s10 offen sc1
    s_mov_b64 exec, -1
    s_add_u32 s60, s62, 139264
    s_and_b32 m0, s60, 0x1ffff
    s_add_u32 s60, s63, 36864
    buffer_load_dwordx4 v5, s[48:51], s60 offen offset:0 sc1 lds
    buffer_load_dwordx4 v5, s[48:51], s60 offen offset:1024 sc1 lds
    buffer_load_dwordx4 v5, s[48:51], s60 offen offset:2048 sc1 lds
    buffer_load_dwordx4 v5, s[48:51], s60 offen offset:3072 sc1 lds
    s_add_u32 s60, s62, 155648
    s_and_b32 m0, s60, 0x1ffff
    s_add_u32 s60, s63, 45056
    buffer_load_dwordx4 v5, s[48:51], s60 offen offset:0 sc1 lds
    buffer_load_dwordx4 v5, s[48:51], s60 offen offset:1024 sc1 lds
    buffer_load_dwordx4 v5, s[48:51], s60 offen offset:2048 sc1 lds
    buffer_load_dwordx4 v5, s[48:51], s60 offen offset:3072 sc1 lds
    s_add_u32 s60, s62, 172032
    s_and_b32 m0, s60, 0x1ffff
    s_add_u32 s60, s63, 53248
    buffer_load_dwordx4 v5, s[48:51], s60 offen offset:0 sc1 lds
    buffer_load_dwordx4 v5, s[48:51], s60 offen offset:1024 sc1 lds
    buffer_load_dwordx4 v5, s[48:51], s60 offen offset:2048 sc1 lds
    buffer_load_dwordx4 v5, s[48:51], s60 offen offset:3072 sc1 lds
    s_add_u32 s60, s62, 180224
    s_and_b32 m0, s60, 0x1ffff
    s_add_u32 s60, s63, 57344
    buffer_load_dwordx4 v5, s[48:51], s60 offen offset:0 sc1 lds
    buffer_load_dwordx4 v5, s[48:51], s60 offen offset:1024 sc1 lds
    buffer_load_dwordx4 v5, s[48:51], s60 offen offset:2048 sc1 lds
    buffer_load_dwordx4 v5, s[48:51], s60 offen offset:3072 sc1 lds
    s_add_u32 m0, s13, 0
    s_nop 0
    buffer_load_dwordx4 v8, s[40:43], s14 offen lds
    buffer_load_dwordx4 v11, s[40:43], s14 offen offset:1024 lds
    s_add_u32 s14, s14, 16384
    s_add_u32 m0, s13, 2048
    s_nop 0
    buffer_load_dwordx4 v8, s[40:43], s14 offen lds
    buffer_load_dwordx4 v11, s[40:43], s14 offen offset:1024 lds
    s_add_u32 s14, s14, 16384
    s_add_u32 m0, s13, 4096
    s_nop 0
    buffer_load_dwordx4 v8, s[40:43], s14 offen lds
    buffer_load_dwordx4 v11, s[40:43], s14 offen offset:1024 lds
    s_add_u32 s14, s14, 16384
    s_and_b32 s60, s4, 7
    s_lshl_b32 s60, s60, 2
    s_add_u32 s60, s60, s12
    s_lshl_b32 s65, s60, 14
    s_mul_i32 s60, s60, 57344
    s_lshl_b32 s61, s5, 7
    s_add_u32 s60, s60, s61
    s_add_u32 s61, s61, s65
    v_lshlrev_b32 v167, 10, v1
    s_mov_b32 exec_hi, 0xffffff
    buffer_load_dword v166, v167, s[40:43], s60 offen
    s_mov_b64 exec, -1
    s_lshl_b32 s10, s7, 8
    s_add_u32 s10, s10, 157696
    v_lshl_add_u32 v6, v1, 2, s10
    ds_read_b32 v14, v6
    ds_read_b32 v15, v6 offset:512
    ds_read_b32 v16, v6 offset:1024
    ds_read_b32 v17, v6 offset:1536
    s_waitcnt lgkmcnt(0)
    v_add_f32 v14, v14, v15
    v_add_f32 v16, v16, v17
    v_add_f32 v14, v14, v16
    v_mul_f32 v14, 0xbfb8aa3b, v14
    v_exp_f32 v14, v14
    s_nop 0
    v_add_f32 v14, 1.0, v14
    v_rcp_f32 v14, v14
    s_nop 0
    v_sub_f32 v15, 1.0, v14
    s_waitcnt vmcnt(7)
    s_mov_b64 exec, 1
    ds_add_u32 v160, v161 offset:12
    s_mov_b64 exec, -1
    s_lshl_b32 s10, s5, 8
    s_add_u32 s9, s9, s10
    s_lshl_b32 s10, s12, 6
    s_add_u32 s9, s9, s10
    s_add_u32 s70, s38, s9
    s_addc_u32 s71, s39, 0
    s_mov_b32 s64, 0
L_p2:
    s_add_u32 s64, s64, 1
    s_cmp_ge_u32 s64, 65536
    s_cbranch_scc1 L_p2_ok
    s_sleep 4
    s_load_dwordx16 s[16:31], s[70:71], 0 glc
    s_waitcnt lgkmcnt(0)
    s_cmp_lg_u64 s[16:17], s[68:69]
    s_cbranch_scc1 L_p2
    s_cmp_lg_u64 s[18:19], s[68:69]
    s_cbranch_scc1 L_p2
    s_cmp_lg_u64 s[20:21], s[68:69]
    s_cbranch_scc1 L_p2
    s_cmp_lg_u64 s[22:23], s[68:69]
    s_cbranch_scc1 L_p2
    s_cmp_lg_u64 s[24:25], s[68:69]
    s_cbranch_scc1 L_p2
    s_cmp_lg_u64 s[26:27], s[68:69]
    s_cbranch_scc1 L_p2
    s_cmp_lg_u64 s[28:29], s[68:69]
    s_cbranch_scc1 L_p2
    s_cmp_lg_u64 s[30:31], s[68:69]
    s_cbranch_scc1 L_p2
L_p2_ok:
    s_waitcnt vmcnt(0)
    s_lshl_b32 s10, s4, 1
    s_add_u32 s10, s10, s7
    s_xor_b32 s11, s10, 1
    s_mul_i32 s10, s10, 114688
    s_mul_i32 s11, s11, 114688
    s_mul_i32 s9, s12, 28672
    s_add_u32 s9, s9, 16777216
    s_add_u32 s10, s10, s9
    s_add_u32 s11, s11, s9
    buffer_load_dwordx4 v[32:35], v5, s[48:51], s10 offen offset:0 sc1
    buffer_load_dwordx4 v[36:39], v5, s[48:51], s11 offen offset:0 sc1
    buffer_load_dwordx4 v[40:43], v5, s[48:51], s10 offen offset:1024 sc1
    buffer_load_dwordx4 v[44:47], v5, s[48:51], s11 offen offset:1024 sc1
    buffer_load_dwordx4 v[48:51], v5, s[48:51], s10 offen offset:2048 sc1
    buffer_load_dwordx4 v[52:55], v5, s[48:51], s11 offen offset:2048 sc1
    buffer_load_dwordx4 v[56:59], v5, s[48:51], s10 offen offset:3072 sc1
    buffer_load_dwordx4 v[60:63], v5, s[48:51], s11 offen offset:3072 sc1
    s_add_u32 s10, s10, 4096
    s_add_u32 s11, s11, 4096
    buffer_load_dwordx4 v[64:67], v5, s[48:51], s10 offen offset:0 sc1
    buffer_load_dwordx4 v[68:71], v5, s[48:51], s11 offen offset:0 sc1
    buffer_load_dwordx4 v[72:75], v5, s[48:51], s10 offen offset:1024 sc1
    buffer_load_dwordx4 v[76:79], v5, s[48:51], s11 offen offset:1024 sc1
    s_setprio 0
    ds_read_b64_tr_b16 v[16:17], v9 offset:0
    ds_read_b64_tr_b16 v[18:19], v9 offset:1024
    ds_read_b64_tr_b16 v[20:21], v10 offset:0
    ds_read_b64_tr_b16 v[22:23], v10 offset:1024
    s_waitcnt lgkmcnt(0) vmcnt(10)
    v_mfma_f32_32x32x16_bf16 v[96:111], v[16:19], v[32:35], 0
    ds_read_b64_tr_b16 v[24:25], v9 offset:2048
    ds_read_b64_tr_b16 v[26:27], v9 offset:3072
    ds_read_b64_tr_b16 v[28:29], v10 offset:2048
    ds_read_b64_tr_b16 v[30:31], v10 offset:3072
    v_mfma_f32_32x32x16_bf16 v[112:127], v[16:19], v[36:39], 0
    s_add_u32 m0, s13, 0
    s_nop 0
    buffer_load_dwordx4 v8, s[40:43], s14 offen lds
    buffer_load_dwordx4 v11, s[40:43], s14 offen offset:1024 lds
    s_add_u32 s14, s14, 16384
    v_mfma_f32_32x32x16_bf16 v[128:143], v[20:23], v[32:35], 0
    v_mfma_f32_32x32x16_bf16 v[144:159], v[20:23], v[36:39], 0
    buffer_load_dwordx4 v[32:35], v5, s[48:51], s10 offen offset:2048 sc1
    buffer_load_dwordx4 v[36:39], v5, s[48:51], s11 offen offset:2048 sc1
    s_waitcnt lgkmcnt(0) vmcnt(12)
    v_mfma_f32_32x32x16_bf16 v[96:111], v[24:27], v[40:43], v[96:111]
    ds_read_b64_tr_b16 v[16:17], v9 offset:4096
    ds_read_b64_tr_b16 v[18:19], v9 offset:5120
    ds_read_b64_tr_b16 v[20:21], v10 offset:4096
    ds_read_b64_tr_b16 v[22:23], v10 offset:5120
    v_mfma_f32_32x32x16_bf16 v[112:127], v[24:27], v[44:47], v[112:127]
    s_add_u32 m0, s13, 2048
    s_nop 0
    buffer_load_dwordx4 v8, s[40:43], s14 offen lds
    buffer_load_dwordx4 v11, s[40:43], s14 offen offset:1024 lds
    s_add_u32 s14, s14, 16384
    v_mfma_f32_32x32x16_bf16 v[128:143], v[28:31], v[40:43], v[128:143]
    v_mfma_f32_32x32x16_bf16 v[144:159], v[28:31], v[44:47], v[144:159]
    buffer_load_dwordx4 v[40:43], v5, s[48:51], s10 offen offset:3072 sc1
    buffer_load_dwordx4 v[44:47], v5, s[48:51], s11 offen offset:3072 sc1
    s_add_u32 s10, s10, 4096
    s_add_u32 s11, s11, 4096
    s_waitcnt lgkmcnt(0) vmcnt(14)
    v_mfma_f32_32x32x16_bf16 v[96:111], v[16:19], v[48:51], v[96:111]
    s_waitcnt vmcnt(6)
    ds_read_b64_tr_b16 v[24:25], v9 offset:0
    ds_read_b64_tr_b16 v[26:27], v9 offset:1024
    ds_read_b64_tr_b16 v[28:29], v10 offset:0
    ds_read_b64_tr_b16 v[30:31], v10 offset:1024
    v_mfma_f32_32x32x16_bf16 v[112:127], v[16:19], v[52:55], v[112:127]
    s_add_u32 m0, s13, 4096
    s_nop 0
    buffer_load_dwordx4 v8, s[40:43], s14 offen lds
    buffer_load_dwordx4 v11, s[40:43], s14 offen offset:1024 lds
    s_add_u32 s14, s14, 16384
    v_mfma_f32_32x32x16_bf16 v[128:143], v[20:23], v[48:51], v[128:143]
    v_mfma_f32_32x32x16_bf16 v[144:159], v[20:23], v[52:55], v[144:159]
    buffer_load_dwordx4 v[48:51], v5, s[48:51], s10 offen offset:0 sc1
    buffer_load_dwordx4 v[52:55], v5, s[48:51], s11 offen offset:0 sc1
    s_waitcnt lgkmcnt(0)
    v_mfma_f32_32x32x16_bf16 v[96:111], v[24:27], v[56:59], v[96:111]
    s_waitcnt vmcnt(6)
    ds_read_b64_tr_b16 v[16:17], v9 offset:2048
    ds_read_b64_tr_b16 v[18:19], v9 offset:3072
    ds_read_b64_tr_b16 v[20:21], v10 offset:2048
    ds_read_b64_tr_b16 v[22:23], v10 offset:3072
    v_mfma_f32_32x32x16_bf16 v[112:127], v[24:27], v[60:63], v[112:127]
    s_add_u32 m0, s13, 0
    s_nop 0
    buffer_load_dwordx4 v8, s[40:43], s14 offen lds
    buffer_load_dwordx4 v11, s[40:43], s14 offen offset:1024 lds
    s_add_u32 s14, s14, 16384
    v_mfma_f32_32x32x16_bf16 v[128:143], v[28:31], v[56:59], v[128:143]
    v_mfma_f32_32x32x16_bf16 v[144:159], v[28:31], v[60:63], v[144:159]
    buffer_load_dwordx4 v[56:59], v5, s[48:51], s10 offen offset:1024 sc1
    buffer_load_dwordx4 v[60:63], v5, s[48:51], s11 offen offset:1024 sc1
    s_waitcnt lgkmcnt(0)
    v_mfma_f32_32x32x16_bf16 v[96:111], v[16:19], v[64:67], v[96:111]
    s_waitcnt vmcnt(6)
    ds_read_b64_tr_b16 v[24:25], v9 offset:4096
    ds_read_b64_tr_b16 v[26:27], v9 offset:5120
    ds_read_b64_tr_b16 v[28:29], v10 offset:4096
    ds_read_b64_tr_b16 v[30:31], v10 offset:5120
    v_mfma_f32_32x32x16_bf16 v[112:127], v[16:19], v[68:71], v[112:127]
    s_add_u32 m0, s13, 2048
    s_nop 0
    buffer_load_dwordx4 v8, s[40:43], s14 offen lds
    buffer_load_dwordx4 v11, s[40:43], s14 offen offset:1024 lds
    s_add_u32 s14, s14, 16384
    v_mfma_f32_32x32x16_bf16 v[128:143], v[20:23], v[64:67], v[128:143]
    v_mfma_f32_32x32x16_bf16 v[144:159], v[20:23], v[68:71], v[144:159]
    buffer_load_dwordx4 v[64:67], v5, s[48:51], s10 offen offset:2048 sc1
    buffer_load_dwordx4 v[68:71], v5, s[48:51], s11 offen offset:2048 sc1
    s_waitcnt lgkmcnt(0)
    v_mfma_f32_32x32x16_bf16 v[96:111], v[24:27], v[72:75], v[96:111]
    s_waitcnt vmcnt(6)
    ds_read_b64_tr_b16 v[16:17], v9 offset:0
    ds_read_b64_tr_b16 v[18:19], v9 offset:1024
    ds_read_b64_tr_b16 v[20:21], v10 offset:0
    ds_read_b64_tr_b16 v[22:23], v10 offset:1024
    v_mfma_f32_32x32x16_bf16 v[112:127], v[24:27], v[76:79], v[112:127]
    s_add_u32 m0, s13, 4096
    s_nop 0
    buffer_load_dwordx4 v8, s[40:43], s14 offen lds
    buffer_load_dwordx4 v11, s[40:43], s14 offen offset:1024 lds
    s_add_u32 s14, s14, 16384
    v_mfma_f32_32x32x16_bf16 v[128:143], v[28:31], v[72:75], v[128:143]
    v_mfma_f32_32x32x16_bf16 v[144:159], v[28:31], v[76:79], v[144:159]
    buffer_load_dwordx4 v[72:75], v5, s[48:51], s10 offen offset:3072 sc1
    buffer_load_dwordx4 v[76:79], v5, s[48:51], s11 offen offset:3072 sc1
    s_add_u32 s10, s10, 4096
    s_add_u32 s11, s11, 4096
    s_waitcnt lgkmcnt(0)
    v_mfma_f32_32x32x16_bf16 v[96:111], v[16:19], v[32:35], v[96:111]
    s_waitcnt vmcnt(6)
    ds_read_b64_tr_b16 v[24:25], v9 offset:2048
    ds_read_b64_tr_b16 v[26:27], v9 offset:3072
    ds_read_b64_tr_b16 v[28:29], v10 offset:2048
    ds_read_b64_tr_b16 v[30:31], v10 offset:3072
    v_mfma_f32_32x32x16_bf16 v[112:127], v[16:19], v[36:39], v[112:127]
    s_add_u32 m0, s13, 0
    s_nop 0
    buffer_load_dwordx4 v8, s[40:43], s14 offen lds
    buffer_load_dwordx4 v11, s[40:43], s14 offen offset:1024 lds
    s_add_u32 s14, s14, 16384
    v_mfma_f32_32x32x16_bf16 v[128:143], v[20:23], v[32:35], v[128:143]
    v_mfma_f32_32x32x16_bf16 v[144:159], v[20:23], v[36:39], v[144:159]
    buffer_load_dwordx4 v[32:35], v5, s[48:51], s10 offen offset:0 sc1
    buffer_load_dwordx4 v[36:39], v5, s[48:51], s11 offen offset:0 sc1
    s_waitcnt lgkmcnt(0)
    v_mfma_f32_32x32x16_bf16 v[96:111], v[24:27], v[40:43], v[96:111]
    s_waitcnt vmcnt(6)
    ds_read_b64_tr_b16 v[16:17], v9 offset:4096
    ds_read_b64_tr_b16 v[18:19], v9 offset:5120
    ds_read_b64_tr_b16 v[20:21], v10 offset:4096
    ds_read_b64_tr_b16 v[22:23], v10 offset:5120
    v_mfma_f32_32x32x16_bf16 v[112:127], v[24:27], v[44:47], v[112:127]
    s_add_u32 m0, s13, 2048
    s_nop 0
    buffer_load_dwordx4 v8, s[40:43], s14 offen lds
    buffer_load_dwordx4 v11, s[40:43], s14 offen offset:1024 lds
    s_add_u32 s14, s14, 16384
    v_mfma_f32_32x32x16_bf16 v[128:143], v[28:31], v[40:43], v[128:143]
    v_mfma_f32_32x32x16_bf16 v[144:159], v[28:31], v[44:47], v[144:159]
    buffer_load_dwordx4 v[40:43], v5, s[48:51], s10 offen offset:1024 sc1
    buffer_load_dwordx4 v[44:47], v5, s[48:51], s11 offen offset:1024 sc1
    s_waitcnt lgkmcnt(0)
    v_mfma_f32_32x32x16_bf16 v[96:111], v[16:19], v[48:51], v[96:111]
    s_waitcnt vmcnt(6)
    ds_read_b64_tr_b16 v[24:25], v9 offset:0
    ds_read_b64_tr_b16 v[26:27], v9 offset:1024
    ds_read_b64_tr_b16 v[28:29], v10 offset:0
    ds_read_b64_tr_b16 v[30:31], v10 offset:1024
    v_mfma_f32_32x32x16_bf16 v[112:127], v[16:19], v[52:55], v[112:127]
    s_add_u32 m0, s13, 4096
    s_nop 0
    buffer_load_dwordx4 v8, s[40:43], s14 offen lds
    buffer_load_dwordx4 v11, s[40:43], s14 offen offset:1024 lds
    s_add_u32 s14, s14, 16384
    v_mfma_f32_32x32x16_bf16 v[128:143], v[20:23], v[48:51], v[128:143]
    s_mov_b64 exec, 0xffff
    buffer_load_dword v166, v167, s[44:47], s61 offen
    s_mov_b64 exec, -1
    v_mfma_f32_32x32x16_bf16 v[144:159], v[20:23], v[52:55], v[144:159]
    buffer_load_dwordx4 v[48:51], v5, s[48:51], s10 offen offset:2048 sc1
    buffer_load_dwordx4 v[52:55], v5, s[48:51], s11 offen offset:2048 sc1
    s_waitcnt lgkmcnt(0)
    v_mfma_f32_32x32x16_bf16 v[96:111], v[24:27], v[56:59], v[96:111]
    s_waitcnt vmcnt(7)
    ds_read_b64_tr_b16 v[16:17], v9 offset:2048
    ds_read_b64_tr_b16 v[18:19], v9 offset:3072
    ds_read_b64_tr_b16 v[20:21], v10 offset:2048
    ds_read_b64_tr_b16 v[22:23], v10 offset:3072
    v_mfma_f32_32x32x16_bf16 v[112:127], v[24:27], v[60:63], v[112:127]
    s_add_u32 m0, s13, 0
    s_nop 0
    buffer_load_dwordx4 v8, s[40:43], s14 offen lds
    buffer_load_dwordx4 v11, s[40:43], s14 offen offset:1024 lds
    s_add_u32 s14, s14, 16384
    v_mfma_f32_32x32x16_bf16 v[128:143], v[28:31], v[56:59], v[128:143]
    v_mfma_f32_32x32x16_bf16 v[144:159], v[28:31], v[60:63], v[144:159]
    buffer_load_dwordx4 v[56:59], v5, s[48:51], s10 offen offset:3072 sc1
    buffer_load_dwordx4 v[60:63], v5, s[48:51], s11 offen offset:3072 sc1
    s_add_u32 s10, s10, 4096
    s_add_u32 s11, s11, 4096
    s_waitcnt lgkmcnt(0)
    v_mfma_f32_32x32x16_bf16 v[96:111], v[16:19], v[64:67], v[96:111]
    s_waitcnt vmcnt(7)
    ds_read_b64_tr_b16 v[24:25], v9 offset:4096
    ds_read_b64_tr_b16 v[26:27], v9 offset:5120
    ds_read_b64_tr_b16 v[28:29], v10 offset:4096
    ds_read_b64_tr_b16 v[30:31], v10 offset:5120
    v_mfma_f32_32x32x16_bf16 v[112:127], v[16:19], v[68:71], v[112:127]
    s_add_u32 m0, s13, 2048
    s_nop 0
    buffer_load_dwordx4 v8, s[40:43], s14 offen lds
    buffer_load_dwordx4 v11, s[40:43], s14 offen offset:1024 lds
    s_add_u32 s14, s14, 16384
    v_mfma_f32_32x32x16_bf16 v[128:143], v[20:23], v[64:67], v[128:143]
    v_mfma_f32_32x32x16_bf16 v[144:159], v[20:23], v[68:71], v[144:159]
    buffer_load_dwordx4 v[64:67], v5, s[48:51], s10 offen offset:0 sc1
    buffer_load_dwordx4 v[68:71], v5, s[48:51], s11 offen offset:0 sc1
    s_waitcnt lgkmcnt(0)
    v_mfma_f32_32x32x16_bf16 v[96:111], v[24:27], v[72:75], v[96:111]
    s_waitcnt vmcnt(6)
    ds_read_b64_tr_b16 v[16:17], v9 offset:0
    ds_read_b64_tr_b16 v[18:19], v9 offset:1024
    ds_read_b64_tr_b16 v[20:21], v10 offset:0
    ds_read_b64_tr_b16 v[22:23], v10 offset:1024
    v_mfma_f32_32x32x16_bf16 v[112:127], v[24:27], v[76:79], v[112:127]
    s_add_u32 m0, s13, 4096
    s_nop 0
    buffer_load_dwordx4 v8, s[40:43], s14 offen lds
    buffer_load_dwordx4 v11, s[40:43], s14 offen offset:1024 lds
    s_add_u32 s14, s14, 16384
    v_mfma_f32_32x32x16_bf16 v[128:143], v[28:31], v[72:75], v[128:143]
    v_mfma_f32_32x32x16_bf16 v[144:159], v[28:31], v[76:79], v[144:159]
    buffer_load_dwordx4 v[72:75], v5, s[48:51], s10 offen offset:1024 sc1
    buffer_load_dwordx4 v[76:79], v5, s[48:51], s11 offen offset:1024 sc1
    s_waitcnt lgkmcnt(0)
    v_mfma_f32_32x32x16_bf16 v[96:111], v[16:19], v[32:35], v[96:111]
    s_waitcnt vmcnt(6)
    ds_read_b64_tr_b16 v[24:25], v9 offset:2048
    ds_read_b64_tr_b16 v[26:27], v9 offset:3072
    ds_read_b64_tr_b16 v[28:29], v10 offset:2048
    ds_read_b64_tr_b16 v[30:31], v10 offset:3072
    v_mfma_f32_32x32x16_bf16 v[112:127], v[16:19], v[36:39], v[112:127]
    s_add_u32 m0, s13, 0
    s_nop 0
    buffer_load_dwordx4 v8, s[40:43], s14 offen lds
    buffer_load_dwordx4 v11, s[40:43], s14 offen offset:1024 lds
    s_add_u32 s14, s14, 16384
    v_mfma_f32_32x32x16_bf16 v[128:143], v[20:23], v[32:35], v[128:143]
    v_mfma_f32_32x32x16_bf16 v[144:159], v[20:23], v[36:39], v[144:159]
    buffer_load_dwordx4 v[32:35], v5, s[48:51], s10 offen offset:2048 sc1
    buffer_load_dwordx4 v[36:39], v5, s[48:51], s11 offen offset:2048 sc1
    s_waitcnt lgkmcnt(0)
    v_mfma_f32_32x32x16_bf16 v[96:111], v[24:27], v[40:43], v[96:111]
    s_waitcnt vmcnt(6)
    ds_read_b64_tr_b16 v[16:17], v9 offset:4096
    ds_read_b64_tr_b16 v[18:19], v9 offset:5120
    ds_read_b64_tr_b16 v[20:21], v10 offset:4096
    ds_read_b64_tr_b16 v[22:23], v10 offset:5120
    v_mfma_f32_32x32x16_bf16 v[112:127], v[24:27], v[44:47], v[112:127]
    s_add_u32 m0, s13, 2048
    s_nop 0
    buffer_load_dwordx4 v8, s[40:43], s14 offen lds
    buffer_load_dwordx4 v11, s[40:43], s14 offen offset:1024 lds
    s_add_u32 s14, s14, 16384
    v_mfma_f32_32x32x16_bf16 v[128:143], v[28:31], v[40:43], v[128:143]
    v_mfma_f32_32x32x16_bf16 v[144:159], v[28:31], v[44:47], v[144:159]
    buffer_load_dwordx4 v[40:43], v5, s[48:51], s10 offen offset:3072 sc1
    buffer_load_dwordx4 v[44:47], v5, s[48:51], s11 offen offset:3072 sc1
    s_add_u32 s10, s10, 4096
    s_add_u32 s11, s11, 4096
    s_waitcnt lgkmcnt(0)
    v_mfma_f32_32x32x16_bf16 v[96:111], v[16:19], v[48:51], v[96:111]
    s_waitcnt vmcnt(6)
    ds_read_b64_tr_b16 v[24:25], v9 offset:0
    ds_read_b64_tr_b16 v[26:27], v9 offset:1024
    ds_read_b64_tr_b16 v[28:29], v10 offset:0
    ds_read_b64_tr_b16 v[30:31], v10 offset:1024
    v_mfma_f32_32x32x16_bf16 v[112:127], v[16:19], v[52:55], v[112:127]
    s_add_u32 m0, s13, 4096
    s_nop 0
    buffer_load_dwordx4 v8, s[40:43], s14 offen lds
    buffer_load_dwordx4 v11, s[40:43], s14 offen offset:1024 lds
    s_add_u32 s14, s14, 16384
    v_mfma_f32_32x32x16_bf16 v[128:143], v[20:23], v[48:51], v[128:143]
    v_mfma_f32_32x32x16_bf16 v[144:159], v[20:23], v[52:55], v[144:159]
    buffer_load_dwordx4 v[48:51], v5, s[48:51], s10 offen offset:0 sc1
    buffer_load_dwordx4 v[52:55], v5, s[48:51], s11 offen offset:0 sc1
    s_waitcnt lgkmcnt(0)
    v_mfma_f32_32x32x16_bf16 v[96:111], v[24:27], v[56:59], v[96:111]
    s_waitcnt vmcnt(6)
    ds_read_b64_tr_b16 v[16:17], v9 offset:2048
    ds_read_b64_tr_b16 v[18:19], v9 offset:3072
    ds_read_b64_tr_b16 v[20:21], v10 offset:2048
    ds_read_b64_tr_b16 v[22:23], v10 offset:3072
    v_mfma_f32_32x32x16_bf16 v[112:127], v[24:27], v[60:63], v[112:127]
    s_add_u32 m0, s13, 0
    s_nop 0
    buffer_load_dwordx4 v8, s[40:43], s14 offen lds
    buffer_load_dwordx4 v11, s[40:43], s14 offen offset:1024 lds
    s_add_u32 s14, s14, 16384
    v_mfma_f32_32x32x16_bf16 v[128:143], v[28:31], v[56:59], v[128:143]
    v_mfma_f32_32x32x16_bf16 v[144:159], v[28:31], v[60:63], v[144:159]
    buffer_load_dwordx4 v[56:59], v5, s[48:51], s10 offen offset:1024 sc1
    buffer_load_dwordx4 v[60:63], v5, s[48:51], s11 offen offset:1024 sc1
    s_waitcnt lgkmcnt(0)
    v_mfma_f32_32x32x16_bf16 v[96:111], v[16:19], v[64:67], v[96:111]
    s_waitcnt vmcnt(6)
    ds_read_b64_tr_b16 v[24:25], v9 offset:4096
    ds_read_b64_tr_b16 v[26:27], v9 offset:5120
    ds_read_b64_tr_b16 v[28:29], v10 offset:4096
    ds_read_b64_tr_b16 v[30:31], v10 offset:5120
    v_mfma_f32_32x32x16_bf16 v[112:127], v[16:19], v[68:71], v[112:127]
    s_add_u32 m0, s13, 2048
    s_nop 0
    buffer_load_dwordx4 v8, s[40:43], s14 offen lds
    buffer_load_dwordx4 v11, s[40:43], s14 offen offset:1024 lds
    s_add_u32 s14, s14, 16384
    v_mfma_f32_32x32x16_bf16 v[128:143], v[20:23], v[64:67], v[128:143]
    v_mfma_f32_32x32x16_bf16 v[144:159], v[20:23], v[68:71], v[144:159]
    buffer_load_dwordx4 v[64:67], v5, s[48:51], s10 offen offset:2048 sc1
    buffer_load_dwordx4 v[68:71], v5, s[48:51], s11 offen offset:2048 sc1
    s_waitcnt lgkmcnt(0)
    v_mfma_f32_32x32x16_bf16 v[96:111], v[24:27], v[72:75], v[96:111]
    s_waitcnt vmcnt(6)
    ds_read_b64_tr_b16 v[16:17], v9 offset:0
    ds_read_b64_tr_b16 v[18:19], v9 offset:1024
    ds_read_b64_tr_b16 v[20:21], v10 offset:0
    ds_read_b64_tr_b16 v[22:23], v10 offset:1024
    v_mfma_f32_32x32x16_bf16 v[112:127], v[24:27], v[76:79], v[112:127]
    s_add_u32 m0, s13, 4096
    s_nop 0
    buffer_load_dwordx4 v8, s[40:43], s14 offen lds
    buffer_load_dwordx4 v11, s[40:43], s14 offen offset:1024 lds
    s_add_u32 s14, s14, 16384
    v_mfma_f32_32x32x16_bf16 v[128:143], v[28:31], v[72:75], v[128:143]
    v_mfma_f32_32x32x16_bf16 v[144:159], v[28:31], v[76:79], v[144:159]
    buffer_load_dwordx4 v[72:75], v5, s[48:51], s10 offen offset:3072 sc1
    buffer_load_dwordx4 v[76:79], v5, s[48:51], s11 offen offset:3072 sc1
    s_add_u32 s10, s10, 4096
    s_add_u32 s11, s11, 4096
    s_waitcnt lgkmcnt(0)
    v_mfma_f32_32x32x16_bf16 v[96:111], v[16:19], v[32:35], v[96:111]
    s_waitcnt vmcnt(6)
    ds_read_b64_tr_b16 v[24:25], v9 offset:2048
    ds_read_b64_tr_b16 v[26:27], v9 offset:3072
    ds_read_b64_tr_b16 v[28:29], v10 offset:2048
    ds_read_b64_tr_b16 v[30:31], v10 offset:3072
    v_mfma_f32_32x32x16_bf16 v[112:127], v[16:19], v[36:39], v[112:127]
    s_add_u32 m0, s13, 0
    s_nop 0
    buffer_load_dwordx4 v8, s[40:43], s14 offen lds
    buffer_load_dwordx4 v11, s[40:43], s14 offen offset:1024 lds
    s_add_u32 s14, s14, 16384
    v_mfma_f32_32x32x16_bf16 v[128:143], v[20:23], v[32:35], v[128:143]
    v_mfma_f32_32x32x16_bf16 v[144:159], v[20:23], v[36:39], v[144:159]
    buffer_load_dwordx4 v[32:35], v5, s[48:51], s10 offen offset:0 sc1
    buffer_load_dwordx4 v[36:39], v5, s[48:51], s11 offen offset:0 sc1
    s_waitcnt lgkmcnt(0)
    v_mfma_f32_32x32x16_bf16 v[96:111], v[24:27], v[40:43], v[96:111]
    s_waitcnt vmcnt(6)
    ds_read_b64_tr_b16 v[16:17], v9 offset:4096
    ds_read_b64_tr_b16 v[18:19], v9 offset:5120
    ds_read_b64_tr_b16 v[20:21], v10 offset:4096
    ds_read_b64_tr_b16 v[22:23], v10 offset:5120
    v_mfma_f32_32x32x16_bf16 v[112:127], v[24:27], v[44:47], v[112:127]
    s_add_u32 m0, s13, 2048
    s_nop 0
    buffer_load_dwordx4 v8, s[40:43], s14 offen lds
    buffer_load_dwordx4 v11, s[40:43], s14 offen offset:1024 lds
    s_add_u32 s14, s14, 16384
    v_mfma_f32_32x32x16_bf16 v[128:143], v[28:31], v[40:43], v[128:143]
    v_mfma_f32_32x32x16_bf16 v[144:159], v[28:31], v[44:47], v[144:159]
    buffer_load_dwordx4 v[40:43], v5, s[48:51], s10 offen offset:1024 sc1
    buffer_load_dwordx4 v[44:47], v5, s[48:51], s11 offen offset:1024 sc1
    s_waitcnt lgkmcnt(0)
    v_mfma_f32_32x32x16_bf16 v[96:111], v[16:19], v[48:51], v[96:111]
    s_waitcnt vmcnt(6)
    ds_read_b64_tr_b16 v[24:25], v9 offset:0
    ds_read_b64_tr_b16 v[26:27], v9 offset:1024
    ds_read_b64_tr_b16 v[28:29], v10 offset:0
    ds_read_b64_tr_b16 v[30:31], v10 offset:1024
    v_mfma_f32_32x32x16_bf16 v[112:127], v[16:19], v[52:55], v[112:127]
    s_add_u32 m0, s13, 4096
    s_nop 0
    buffer_load_dwordx4 v8, s[40:43], s14 offen lds
    buffer_load_dwordx4 v11, s[40:43], s14 offen offset:1024 lds
    s_add_u32 s14, s14, 16384
    v_mfma_f32_32x32x16_bf16 v[128:143], v[20:23], v[48:51], v[128:143]
    v_mfma_f32_32x32x16_bf16 v[144:159], v[20:23], v[52:55], v[144:159]
    buffer_load_dwordx4 v[48:51], v5, s[48:51], s10 offen offset:2048 sc1
    buffer_load_dwordx4 v[52:55], v5, s[48:51], s11 offen offset:2048 sc1
    s_waitcnt lgkmcnt(0)
    v_mfma_f32_32x32x16_bf16 v[96:111], v[24:27], v[56:59], v[96:111]
    s_waitcnt vmcnt(6)
    ds_read_b64_tr_b16 v[16:17], v9 offset:2048
    ds_read_b64_tr_b16 v[18:19], v9 offset:3072
    ds_read_b64_tr_b16 v[20:21], v10 offset:2048
    ds_read_b64_tr_b16 v[22:23], v10 offset:3072
    v_mfma_f32_32x32x16_bf16 v[112:127], v[24:27], v[60:63], v[112:127]
    s_add_u32 m0, s13, 0
    s_nop 0
    buffer_load_dwordx4 v8, s[40:43], s14 offen lds
    buffer_load_dwordx4 v11, s[40:43], s14 offen offset:1024 lds
    s_add_u32 s14, s14, 16384
    v_mfma_f32_32x32x16_bf16 v[128:143], v[28:31], v[56:59], v[128:143]
    v_mfma_f32_32x32x16_bf16 v[144:159], v[28:31], v[60:63], v[144:159]
    buffer_load_dwordx4 v[56:59], v5, s[48:51], s10 offen offset:3072 sc1
    buffer_load_dwordx4 v[60:63], v5, s[48:51], s11 offen offset:3072 sc1
    s_add_u32 s10, s10, 4096
    s_add_u32 s11, s11, 4096
    s_waitcnt lgkmcnt(0)
    v_mfma_f32_32x32x16_bf16 v[96:111], v[16:19], v[64:67], v[96:111]
    s_waitcnt vmcnt(6)
    ds_read_b64_tr_b16 v[24:25], v9 offset:4096
    ds_read_b64_tr_b16 v[26:27], v9 offset:5120
    ds_read_b64_tr_b16 v[28:29], v10 offset:4096
    ds_read_b64_tr_b16 v[30:31], v10 offset:5120
    v_mfma_f32_32x32x16_bf16 v[112:127], v[16:19], v[68:71], v[112:127]
    s_add_u32 m0, s13, 2048
    s_nop 0
    buffer_load_dwordx4 v8, s[40:43], s14 offen lds
    buffer_load_dwordx4 v11, s[40:43], s14 offen offset:1024 lds
    s_add_u32 s14, s14, 16384
    v_mfma_f32_32x32x16_bf16 v[128:143], v[20:23], v[64:67], v[128:143]
    v_mfma_f32_32x32x16_bf16 v[144:159], v[20:23], v[68:71], v[144:159]
    s_waitcnt lgkmcnt(0)
    v_mfma_f32_32x32x16_bf16 v[96:111], v[24:27], v[72:75], v[96:111]
    s_waitcnt vmcnt(4)
    ds_read_b64_tr_b16 v[16:17], v9 offset:0
    ds_read_b64_tr_b16 v[18:19], v9 offset:1024
    ds_read_b64_tr_b16 v[20:21], v10 offset:0
    ds_read_b64_tr_b16 v[22:23], v10 offset:1024
    v_mfma_f32_32x32x16_bf16 v[112:127], v[24:27], v[76:79], v[112:127]
    s_add_u32 m0, s13, 4096
    s_nop 0
    buffer_load_dwordx4 v8, s[40:43], s14 offen lds
    buffer_load_dwordx4 v11, s[40:43], s14 offen offset:1024 lds
    s_add_u32 s14, s14, 16384
    v_mfma_f32_32x32x16_bf16 v[128:143], v[28:31], v[72:75], v[128:143]
    v_mfma_f32_32x32x16_bf16 v[144:159], v[28:31], v[76:79], v[144:159]
    s_waitcnt lgkmcnt(0)
    v_mfma_f32_32x32x16_bf16 v[96:111], v[16:19], v[32:35], v[96:111]
    s_waitcnt vmcnt(2)
    ds_read_b64_tr_b16 v[24:25], v9 offset:2048
    ds_read_b64_tr_b16 v[26:27], v9 offset:3072
    ds_read_b64_tr_b16 v[28:29], v10 offset:2048
    ds_read_b64_tr_b16 v[30:31], v10 offset:3072
    v_mfma_f32_32x32x16_bf16 v[112:127], v[16:19], v[36:39], v[112:127]
    s_add_u32 m0, s13, 0
    s_nop 0
    buffer_load_dwordx4 v8, s[40:43], s14 offen lds
    buffer_load_dwordx4 v11, s[40:43], s14 offen offset:1024 lds
    s_add_u32 s14, s14, 16384
    v_mfma_f32_32x32x16_bf16 v[128:143], v[20:23], v[32:35], v[128:143]
    v_mfma_f32_32x32x16_bf16 v[144:159], v[20:23], v[36:39], v[144:159]
    s_waitcnt lgkmcnt(0)
    v_mfma_f32_32x32x16_bf16 v[96:111], v[24:27], v[40:43], v[96:111]
    s_waitcnt vmcnt(2)
    ds_read_b64_tr_b16 v[16:17], v9 offset:4096
    ds_read_b64_tr_b16 v[18:19], v9 offset:5120
    ds_read_b64_tr_b16 v[20:21], v10 offset:4096
    ds_read_b64_tr_b16 v[22:23], v10 offset:5120
    v_mfma_f32_32x32x16_bf16 v[112:127], v[24:27], v[44:47], v[112:127]
    v_mfma_f32_32x32x16_bf16 v[128:143], v[28:31], v[40:43], v[128:143]
    v_mfma_f32_32x32x16_bf16 v[144:159], v[28:31], v[44:47], v[144:159]
    s_waitcnt lgkmcnt(0)
    v_mfma_f32_32x32x16_bf16 v[96:111], v[16:19], v[48:51], v[96:111]
    s_waitcnt vmcnt(0)
    ds_read_b64_tr_b16 v[24:25], v9 offset:0
    ds_read_b64_tr_b16 v[26:27], v9 offset:1024
    ds_read_b64_tr_b16 v[28:29], v10 offset:0
    ds_read_b64_tr_b16 v[30:31], v10 offset:1024
    v_mfma_f32_32x32x16_bf16 v[112:127], v[16:19], v[52:55], v[112:127]
    v_mfma_f32_32x32x16_bf16 v[128:143], v[20:23], v[48:51], v[128:143]
    v_mfma_f32_32x32x16_bf16 v[144:159], v[20:23], v[52:55], v[144:159]
    s_waitcnt lgkmcnt(0)
    v_mfma_f32_32x32x16_bf16 v[96:111], v[24:27], v[56:59], v[96:111]
    v_mfma_f32_32x32x16_bf16 v[112:127], v[24:27], v[60:63], v[112:127]
    v_mfma_f32_32x32x16_bf16 v[128:143], v[28:31], v[56:59], v[128:143]
    v_mfma_f32_32x32x16_bf16 v[144:159], v[28:31], v[60:63], v[144:159]
    s_setprio 3
    v_lshlrev_b32 v6, 5, v4
    buffer_load_dwordx4 v[16:19], v6, s[52:55], s15 offen
    buffer_load_dwordx4 v[20:23], v6, s[52:55], s15 offen offset:16
    v_add_u32 v8, s13, v5
    s_xor_b32 s9, s12, 1
    s_mul_i32 s9, s9, 6144
    s_add_u32 s9, s9, 131072
    v_add_u32 v9, s9, v5
    s_xor_b32 s9, s12, 2
    s_mul_i32 s9, s9, 6144
    s_add_u32 s9, s9, 133120
    v_add_u32 v10, s9, v5
    s_xor_b32 s9, s12, 3
    s_mul_i32 s9, s9, 6144
    s_add_u32 s9, s9, 135168
    v_add_u32 v11, s9, v5
    ds_write_b128 v8, v[112:115] offset:0
    ds_write_b128 v8, v[116:119] offset:1024
    ds_write_b128 v8, v[128:131] offset:2048
    ds_write_b128 v8, v[132:135] offset:3072
    ds_write_b128 v8, v[144:147] offset:4096
    ds_write_b128 v8, v[148:151] offset:5120
    s_waitcnt lgkmcnt(0)
    s_mov_b64 exec, 1
    ds_add_u32 v160, v161 offset:16
    s_mov_b64 exec, -1
    s_mov_b32 s64, 0
    s_branch L_bs2_1
L_bs2:
    s_sleep 2
L_bs2_1:
    ds_read_b32 v7, v160 offset:16
    s_add_u32 s64, s64, 1
    s_waitcnt lgkmcnt(0)
    v_readfirstlane_b32 s9, v7
    s_lshr_b32 s65, s64, 18
    s_add_u32 s9, s9, s65
    s_cmp_lt_u32 s9, 8
    s_cbranch_scc1 L_bs2
    ds_read_b128 v[32:35], v9 offset:0
    ds_read_b128 v[36:39], v9 offset:1024
    ds_read_b128 v[40:43], v10 offset:0
    ds_read_b128 v[44:47], v10 offset:1024
    ds_read_b128 v[48:51], v11 offset:0
    ds_read_b128 v[52:55], v11 offset:1024
    s_waitcnt lgkmcnt(0)
    s_mov_b64 exec, 1
    ds_add_u32 v160, v161 offset:16
    s_mov_b64 exec, -1
    s_mov_b32 s64, 0
    s_branch L_bs3_1
L_bs3:
    s_sleep 2
L_bs3_1:
    ds_read_b32 v7, v160 offset:16
    s_add_u32 s64, s64, 1
    s_waitcnt lgkmcnt(0)
    v_readfirstlane_b32 s9, v7
    s_lshr_b32 s65, s64, 18
    s_add_u32 s9, s9, s65
    s_cmp_lt_u32 s9, 12
    s_cbranch_scc1 L_bs3
    v_pk_add_f32 v[32:33], v[32:33], v[40:41]
    v_pk_add_f32 v[96:97], v[96:97], v[48:49]
    v_pk_add_f32 v[96:97], v[96:97], v[32:33]
    v_pk_add_f32 v[34:35], v[34:35], v[42:43]
    v_pk_add_f32 v[98:99], v[98:99], v[50:51]
    v_pk_add_f32 v[98:99], v[98:99], v[34:35]
    v_pk_add_f32 v[36:37], v[36:37], v[44:45]
    v_pk_add_f32 v[100:101], v[100:101], v[52:53]
    v_pk_add_f32 v[100:101], v[100:101], v[36:37]
    v_pk_add_f32 v[38:39], v[38:39], v[46:47]
    v_pk_add_f32 v[102:103], v[102:103], v[54:55]
    v_pk_add_f32 v[102:103], v[102:103], v[38:39]
    ds_write_b128 v8, v[120:123] offset:0
    ds_write_b128 v8, v[124:127] offset:1024
    ds_write_b128 v8, v[136:139] offset:2048
    ds_write_b128 v8, v[140:143] offset:3072
    ds_write_b128 v8, v[152:155] offset:4096
    ds_write_b128 v8, v[156:159] offset:5120
    s_waitcnt lgkmcnt(0)
    s_mov_b64 exec, 1
    ds_add_u32 v160, v161 offset:16
    s_mov_b64 exec, -1
    s_mov_b32 s64, 0
    s_branch L_bs4_1
L_bs4:
    s_sleep 2
L_bs4_1:
    ds_read_b32 v7, v160 offset:16
    s_add_u32 s64, s64, 1
    s_waitcnt lgkmcnt(0)
    v_readfirstlane_b32 s9, v7
    s_lshr_b32 s65, s64, 18
    s_add_u32 s9, s9, s65
    s_cmp_lt_u32 s9, 16
    s_cbranch_scc1 L_bs4
    ds_read_b128 v[32:35], v9 offset:0
    ds_read_b128 v[36:39], v9 offset:1024
    ds_read_b128 v[40:43], v10 offset:0
    ds_read_b128 v[44:47], v10 offset:1024
    ds_read_b128 v[48:51], v11 offset:0
    ds_read_b128 v[52:55], v11 offset:1024
    s_waitcnt lgkmcnt(0)
    s_mov_b64 exec, 1
    ds_add_u32 v160, v161 offset:16
    s_mov_b64 exec, -1
    s_mov_b32 s64, 0
    s_branch L_bs5_1
L_bs5:
    s_sleep 2
L_bs5_1:
    ds_read_b32 v7, v160 offset:16
    s_add_u32 s64, s64, 1
    s_waitcnt lgkmcnt(0)
    v_readfirstlane_b32 s9, v7
    s_lshr_b32 s65, s64, 18
    s_add_u32 s9, s9, s65
    s_cmp_lt_u32 s9, 20
    s_cbranch_scc1 L_bs5
    v_pk_add_f32 v[32:33], v[32:33], v[40:41]
    v_pk_add_f32 v[104:105], v[104:105], v[48:49]
    v_pk_add_f32 v[104:105], v[104:105], v[32:33]
    v_pk_add_f32 v[34:35], v[34:35], v[42:43]
    v_pk_add_f32 v[106:107], v[106:107], v[50:51]
    v_pk_add_f32 v[106:107], v[106:107], v[34:35]
    v_pk_add_f32 v[36:37], v[36:37], v[44:45]
    v_pk_add_f32 v[108:109], v[108:109], v[52:53]
    v_pk_add_f32 v[108:109], v[108:109], v[36:37]
    v_pk_add_f32 v[38:39], v[38:39], v[46:47]
    v_pk_add_f32 v[110:111], v[110:111], v[54:55]
    v_pk_add_f32 v[110:111], v[110:111], v[38:39]
    s_waitcnt vmcnt(0)
    v_lshlrev_b32 v24, 16, v16
    v_and_b32 v25, 0xffff0000, v16
    v_add_f32 v24, v24, v96
    v_add_f32 v25, v25, v97
    v_mul_f32 v144, v24, v15
    v_mul_f32 v145, v25, v15
    v_lshlrev_b32 v24, 16, v17
    v_and_b32 v25, 0xffff0000, v17
    v_add_f32 v24, v24, v98
    v_add_f32 v25, v25, v99
    v_mul_f32 v146, v24, v15
    v_mul_f32 v147, v25, v15
    v_lshlrev_b32 v24, 16, v18
    v_and_b32 v25, 0xffff0000, v18
    v_add_f32 v24, v24, v100
    v_add_f32 v25, v25, v101
    v_mul_f32 v148, v24, v15
    v_mul_f32 v149, v25, v15
    v_lshlrev_b32 v24, 16, v19
    v_and_b32 v25, 0xffff0000, v19
    v_add_f32 v24, v24, v102
    v_add_f32 v25, v25, v103
    v_mul_f32 v150, v24, v15
    v_mul_f32 v151, v25, v15
    v_lshlrev_b32 v24, 16, v20
    v_and_b32 v25, 0xffff0000, v20
    v_add_f32 v24, v24, v104
    v_add_f32 v25, v25, v105
    v_mul_f32 v152, v24, v15
    v_mul_f32 v153, v25, v15
    v_lshlrev_b32 v24, 16, v21
    v_and_b32 v25, 0xffff0000, v21
    v_add_f32 v24, v24, v106
    v_add_f32 v25, v25, v107
    v_mul_f32 v154, v24, v15
    v_mul_f32 v155, v25, v15
    v_lshlrev_b32 v24, 16, v22
    v_and_b32 v25, 0xffff0000, v22
    v_add_f32 v24, v24, v108
    v_add_f32 v25, v25, v109
    v_mul_f32 v156, v24, v15
    v_mul_f32 v157, v25, v15
    v_lshlrev_b32 v24, 16, v23
    v_and_b32 v25, 0xffff0000, v23
    v_add_f32 v24, v24, v110
    v_add_f32 v25, v25, v111
    v_mul_f32 v158, v24, v15
    v_mul_f32 v159, v25, v15
    v_lshrrev_b32 v6, 2, v1
    v_lshlrev_b32 v8, 10, v6
    v_and_b32 v6, 3, v1
    v_lshl_add_u32 v8, v6, 4, v8
    s_mov_b32 s14, s15
    s_add_u32 m0, s13, 0
    s_nop 0
    buffer_load_dwordx4 v8, s[44:47], s14 offen lds
    s_add_u32 s14, s14, 16384
    s_add_u32 m0, s13, 1024
    s_nop 0
    buffer_load_dwordx4 v8, s[44:47], s14 offen lds
    s_add_u32 s14, s14, 16384
    s_add_u32 m0, s13, 2048
    s_nop 0
    buffer_load_dwordx4 v8, s[44:47], s14 offen lds
    s_add_u32 s14, s14, 16384
    s_add_u32 m0, s13, 3072
    s_nop 0
    buffer_load_dwordx4 v8, s[44:47], s14 offen lds
    s_add_u32 s14, s14, 16384
    s_add_u32 m0, s13, 4096
    s_nop 0
    buffer_load_dwordx4 v8, s[44:47], s14 offen lds
    s_add_u32 s14, s14, 16384
    s_add_u32 m0, s13, 5120
    s_nop 0
    buffer_load_dwordx4 v8, s[44:47], s14 offen lds
    s_add_u32 s14, s14, 16384
    s_waitcnt vmcnt(4)
    ds_read_b64_tr_b16 v[24:25], v12 offset:0
    ds_read_b64_tr_b16 v[26:27], v12 offset:512
    ds_read_b64_tr_b16 v[28:29], v12 offset:1024
    ds_read_b64_tr_b16 v[30:31], v12 offset:1536
    s_waitcnt lgkmcnt(0)
    s_add_u32 m0, s13, 0
    s_nop 0
    buffer_load_dwordx4 v8, s[44:47], s14 offen lds
    s_add_u32 s14, s14, 16384
    s_add_u32 m0, s13, 1024
    s_nop 0
    buffer_load_dwordx4 v8, s[44:47], s14 offen lds
    s_add_u32 s14, s14, 16384
    s_waitcnt vmcnt(4)
    ds_read_b64_tr_b16 v[32:33], v12 offset:2048
    ds_read_b64_tr_b16 v[34:35], v12 offset:2560
    ds_read_b64_tr_b16 v[36:37], v12 offset:3072
    ds_read_b64_tr_b16 v[38:39], v12 offset:3584
    s_waitcnt lgkmcnt(0)
    s_add_u32 m0, s13, 2048
    s_nop 0
    buffer_load_dwordx4 v8, s[44:47], s14 offen lds
    s_add_u32 s14, s14, 16384
    s_add_u32 m0, s13, 3072
    s_nop 0
    buffer_load_dwordx4 v8, s[44:47], s14 offen lds
    s_add_u32 s14, s14, 16384
    s_waitcnt vmcnt(4)
    ds_read_b64_tr_b16 v[40:41], v12 offset:4096
    ds_read_b64_tr_b16 v[42:43], v12 offset:4608
    ds_read_b64_tr_b16 v[44:45], v12 offset:5120
    ds_read_b64_tr_b16 v[46:47], v12 offset:5632
    s_waitcnt lgkmcnt(0)
    s_add_u32 m0, s13, 4096
    s_nop 0
    buffer_load_dwordx4 v8, s[44:47], s14 offen lds
    s_add_u32 s14, s14, 16384
    s_add_u32 m0, s13, 5120
    s_nop 0
    buffer_load_dwordx4 v8, s[44:47], s14 offen lds
    s_add_u32 s14, s14, 16384
    s_waitcnt vmcnt(4)
    ds_read_b64_tr_b16 v[48:49], v12 offset:0
    ds_read_b64_tr_b16 v[50:51], v12 offset:512
    ds_read_b64_tr_b16 v[52:53], v12 offset:1024
    ds_read_b64_tr_b16 v[54:55], v12 offset:1536
    s_waitcnt lgkmcnt(0)
    s_add_u32 m0, s13, 0
    s_nop 0
    buffer_load_dwordx4 v8, s[44:47], s14 offen lds
    s_add_u32 s14, s14, 16384
    s_add_u32 m0, s13, 1024
    s_nop 0
    buffer_load_dwordx4 v8, s[44:47], s14 offen lds
    s_add_u32 s14, s14, 16384
    s_waitcnt vmcnt(4)
    ds_read_b64_tr_b16 v[56:57], v12 offset:2048
    ds_read_b64_tr_b16 v[58:59], v12 offset:2560
    ds_read_b64_tr_b16 v[60:61], v12 offset:3072
    ds_read_b64_tr_b16 v[62:63], v12 offset:3584
    s_waitcnt lgkmcnt(0)
    s_add_u32 m0, s13, 2048
    s_nop 0
    buffer_load_dwordx4 v8, s[44:47], s14 offen lds
    s_add_u32 s14, s14, 16384
    s_add_u32 m0, s13, 3072
    s_nop 0
    buffer_load_dwordx4 v8, s[44:47], s14 offen lds
    s_add_u32 s14, s14, 16384
    s_waitcnt vmcnt(4)
    ds_read_b64_tr_b16 v[64:65], v12 offset:4096
    ds_read_b64_tr_b16 v[66:67], v12 offset:4608
    ds_read_b64_tr_b16 v[68:69], v12 offset:5120
    ds_read_b64_tr_b16 v[70:71], v12 offset:5632
    s_waitcnt lgkmcnt(0)
    s_add_u32 m0, s13, 4096
    s_nop 0
    buffer_load_dwordx4 v8, s[44:47], s14 offen lds
    s_add_u32 s14, s14, 16384
    s_add_u32 m0, s13, 5120
    s_nop 0
    buffer_load_dwordx4 v8, s[44:47], s14 offen lds
    s_add_u32 s14, s14, 16384
    s_waitcnt vmcnt(4)
    ds_read_b64_tr_b16 v[72:73], v12 offset:0
    ds_read_b64_tr_b16 v[74:75], v12 offset:512
    ds_read_b64_tr_b16 v[76:77], v12 offset:1024
    ds_read_b64_tr_b16 v[78:79], v12 offset:1536
    s_waitcnt lgkmcnt(0)
    s_add_u32 m0, s13, 0
    s_nop 0
    buffer_load_dwordx4 v8, s[44:47], s14 offen lds
    s_add_u32 s14, s14, 16384
    s_add_u32 m0, s13, 1024
    s_nop 0
    buffer_load_dwordx4 v8, s[44:47], s14 offen lds
    s_add_u32 s14, s14, 16384
    s_waitcnt vmcnt(4)
    ds_read_b64_tr_b16 v[80:81], v12 offset:2048
    ds_read_b64_tr_b16 v[82:83], v12 offset:2560
    ds_read_b64_tr_b16 v[84:85], v12 offset:3072
    ds_read_b64_tr_b16 v[86:87], v12 offset:3584
    s_waitcnt lgkmcnt(0)
    s_add_u32 m0, s13, 2048
    s_nop 0
    buffer_load_dwordx4 v8, s[44:47], s14 offen lds
    s_add_u32 s14, s14, 16384
    s_add_u32 m0, s13, 3072
    s_nop 0
    buffer_load_dwordx4 v8, s[44:47], s14 offen lds
    s_add_u32 s14, s14, 16384
    s_waitcnt vmcnt(4)
    ds_read_b64_tr_b16 v[88:89], v12 offset:4096
    ds_read_b64_tr_b16 v[90:91], v12 offset:4608
    ds_read_b64_tr_b16 v[92:93], v12 offset:5120
    ds_read_b64_tr_b16 v[94:95], v12 offset:5632
    s_waitcnt lgkmcnt(0)
    s_add_u32 m0, s13, 4096
    s_nop 0
    buffer_load_dwordx4 v8, s[44:47], s14 offen lds
    s_add_u32 s14, s14, 16384
    s_add_u32 m0, s13, 5120
    s_nop 0
    buffer_load_dwordx4 v8, s[44:47], s14 offen lds
    s_add_u32 s14, s14, 16384
    s_waitcnt vmcnt(4)
    ds_read_b64_tr_b16 v[96:97], v12 offset:0
    ds_read_b64_tr_b16 v[98:99], v12 offset:512
    ds_read_b64_tr_b16 v[100:101], v12 offset:1024
    ds_read_b64_tr_b16 v[102:103], v12 offset:1536
    s_waitcnt lgkmcnt(0)
    s_add_u32 m0, s13, 0
    s_nop 0
    buffer_load_dwordx4 v8, s[44:47], s14 offen lds
    s_add_u32 s14, s14, 16384
    s_add_u32 m0, s13, 1024
    s_nop 0
    buffer_load_dwordx4 v8, s[44:47], s14 offen lds
    s_add_u32 s14, s14, 16384
    s_waitcnt vmcnt(4)
    ds_read_b64_tr_b16 v[104:105], v12 offset:2048
    ds_read_b64_tr_b16 v[106:107], v12 offset:2560
    ds_read_b64_tr_b16 v[108:109], v12 offset:3072
    ds_read_b64_tr_b16 v[110:111], v12 offset:3584
    s_waitcnt lgkmcnt(0)
    s_add_u32 m0, s13, 2048
    s_nop 0
    buffer_load_dwordx4 v8, s[44:47], s14 offen lds
    s_add_u32 s14, s14, 16384
    s_add_u32 m0, s13, 3072
    s_nop 0
    buffer_load_dwordx4 v8, s[44:47], s14 offen lds
    s_add_u32 s14, s14, 16384
    s_waitcnt vmcnt(4)
    ds_read_b64_tr_b16 v[112:113], v12 offset:4096
    ds_read_b64_tr_b16 v[114:115], v12 offset:4608
    ds_read_b64_tr_b16 v[116:117], v12 offset:5120
    ds_read_b64_tr_b16 v[118:119], v12 offset:5632
    s_waitcnt lgkmcnt(0)
    s_add_u32 m0, s13, 4096
    s_nop 0
    buffer_load_dwordx4 v8, s[44:47], s14 offen lds
    s_add_u32 s14, s14, 16384
    s_add_u32 m0, s13, 5120
    s_nop 0
    buffer_load_dwordx4 v8, s[44:47], s14 offen lds
    s_add_u32 s14, s14, 16384
    s_waitcnt vmcnt(4)
    ds_read_b64_tr_b16 v[120:121], v12 offset:0
    ds_read_b64_tr_b16 v[122:123], v12 offset:512
    ds_read_b64_tr_b16 v[124:125], v12 offset:1024
    ds_read_b64_tr_b16 v[126:127], v12 offset:1536
    s_waitcnt lgkmcnt(0)
    s_add_u32 m0, s13, 0
    s_nop 0
    buffer_load_dwordx4 v8, s[44:47], s14 offen lds
    s_add_u32 s14, s14, 16384
    s_add_u32 m0, s13, 1024
    s_nop 0
    buffer_load_dwordx4 v8, s[44:47], s14 offen lds
    s_add_u32 s14, s14, 16384
    s_lshl_b32 s9, s4, 3
    s_add_u32 s9, s9, s5
    s_lshl_b32 s9, s9, 9
    s_lshl_b32 s10, s7, 8
    s_add_u32 s9, s9, s10
    s_lshl_b32 s10, s8, 7
    s_add_u32 s9, s9, s10
    s_add_u32 s9, s9, 11010048
    s_add_u32 s70, s38, s9
    s_addc_u32 s71, s39, 0
    s_lshl_b32 s10, s4, 1
    s_add_u32 s10, s10, s7
    s_lshl_b32 s60, s10, 15
    s_lshl_b32 s11, s8, 14
    s_add_u32 s10, s60, s11
    s_add_u32 s10, s10, 8388608
    s_lshl_b32 s61, s7, 15
    s_add_u32 s61, s61, 65536
    v_add_u32 v11, s61, v5
    s_sub_u32 s14, s10, s11
    s_add_u32 s11, s11, s61
    s_add_u32 s60, s60, s15
    v_lshlrev_b32 v10, 10, v3
    v_lshl_add_u32 v10, v4, 5, v10
    v_lshlrev_b32 v6, 3, v1
    s_mov_b32 s64, 0
    s_branch L_bad_1
L_bad:
    s_sleep 8
L_bad_1:
    ds_read_b32 v7, v160 offset:20
    s_add_u32 s64, s64, 1
    s_waitcnt lgkmcnt(0)
    v_readfirstlane_b32 s63, v7
    s_lshr_b32 s65, s64, 18
    s_add_u32 s63, s63, s65
    s_cmp_lt_u32 s63, 8
    s_cbranch_scc1 L_bad
    s_mov_b32 s62, 0xffff
    s_mov_b32 s64, 0
L_f0s:
    s_sleep 2
L_f0:
    s_load_dwordx16 s[16:31], s[70:71], 0 glc
    s_load_dwordx16 s[32:47], s[70:71], 64 glc
    s_add_u32 s64, s64, 1
    s_cmp_ge_u32 s64, 65536
    s_cselect_b32 s63, -1, 0
    s_waitcnt lgkmcnt(0)
    s_cmp_eq_u64 s[16:17], s[68:69]
    s_cselect_b32 s65, 1, 0
    s_or_b32 s63, s63, s65
    s_cmp_eq_u64 s[18:19], s[68:69]
    s_cselect_b32 s65, 2, 0
    s_or_b32 s63, s63, s65
    s_cmp_eq_u64 s[20:21], s[68:69]
    s_cselect_b32 s65, 4, 0
    s_or_b32 s63, s63, s65
    s_cmp_eq_u64 s[22:23], s[68:69]
    s_cselect_b32 s65, 8, 0
    s_or_b32 s63, s63, s65
    s_cmp_eq_u64 s[24:25], s[68:69]
    s_cselect_b32 s65, 16, 0
    s_or_b32 s63, s63, s65
    s_cmp_eq_u64 s[26:27], s[68:69]
    s_cselect_b32 s65, 32, 0
    s_or_b32 s63, s63, s65
    s_cmp_eq_u64 s[28:29], s[68:69]
    s_cselect_b32 s65, 64, 0
    s_or_b32 s63, s63, s65
    s_cmp_eq_u64 s[30:31], s[68:69]
    s_cselect_b32 s65, 128, 0
    s_or_b32 s63, s63, s65
    s_cmp_eq_u64 s[32:33], s[68:69]
    s_cselect_b32 s65, 256, 0
    s_or_b32 s63, s63, s65
    s_cmp_eq_u64 s[34:35], s[68:69]
    s_cselect_b32 s65, 512, 0
    s_or_b32 s63, s63, s65
    s_cmp_eq_u64 s[36:37], s[68:69]
    s_cselect_b32 s65, 1024, 0
    s_or_b32 s63, s63, s65
    s_cmp_eq_u64 s[38:39], s[68:69]
    s_cselect_b32 s65, 2048, 0
    s_or_b32 s63, s63, s65
    s_cmp_eq_u64 s[40:41], s[68:69]
    s_cselect_b32 s65, 4096, 0
    s_or_b32 s63, s63, s65
    s_cmp_eq_u64 s[42:43], s[68:69]
    s_cselect_b32 s65, 8192, 0
    s_or_b32 s63, s63, s65
    s_cmp_eq_u64 s[44:45], s[68:69]
    s_cselect_b32 s65, 16384, 0
    s_or_b32 s63, s63, s65
    s_cmp_eq_u64 s[46:47], s[68:69]
    s_cselect_b32 s65, 32768, 0
    s_or_b32 s63, s63, s65
    s_and_b32 s63, s63, s62
    s_andn2_b32 s62, s62, s63
L_f1:
    s_cmp_eq_u32 s63, 0
    s_cbranch_scc1 L_f2b
    s_ff1_i32_b32 s65, s63
    s_bitset0_b32 s63, s65
    s_lshl_b32 s65, s65, 10
    s_add_u32 m0, s11, s65
    s_add_u32 s65, s65, s10
    buffer_load_dwordx4 v5, s[48:51], s65 offen sc1 lds
    s_branch L_f1
L_f2b:
    s_cmp_lg_u32 s62, 0
    s_cbranch_scc1 L_f0s
    s_waitcnt vmcnt(0)
    s_waitcnt lgkmcnt(0)
    s_mov_b64 exec, 1
    ds_add_u32 v160, v161 offset:16
    s_mov_b64 exec, -1
    s_mov_b32 s64, 0
    s_branch L_bs6_1
L_bs6:
    s_sleep 2
L_bs6_1:
    ds_read_b32 v7, v160 offset:16
    s_add_u32 s64, s64, 1
    s_waitcnt lgkmcnt(0)
    v_readfirstlane_b32 s9, v7
    s_lshr_b32 s65, s64, 18
    s_add_u32 s9, s9, s65
    s_cmp_lt_u32 s9, 24
    s_cbranch_scc1 L_bs6
    s_mov_b32 s64, 0
L_fm:
    v_mov_b32 v162, 0
    ds_read_b128 v[16:19], v11 offset:0
    ds_read_b128 v[20:23], v11 offset:1024
    ds_read_b64_tr_b16 v[164:165], v12 offset:2048
    ds_read_b64_tr_b16 v[166:167], v12 offset:2560
    ds_read_b64_tr_b16 v[0:1], v12 offset:3072
    ds_read_b64_tr_b16 v[2:3], v12 offset:3584
    ds_read_b128 v[6:9], v11 offset:2048
    s_waitcnt lgkmcnt(6)
    v_mfma_f32_32x32x16_bf16 v[128:143], v[24:27], v[16:19], 0
    v_max3_u32 v162, v162, v16, v17
    v_max3_u32 v162, v162, v18, v19
    ds_read_b128 v[16:19], v11 offset:3072
    s_waitcnt lgkmcnt(6)
    v_mfma_f32_32x32x16_bf16 v[128:143], v[28:31], v[20:23], v[128:143]
    v_max3_u32 v162, v162, v20, v21
    v_max3_u32 v162, v162, v22, v23
    ds_read_b128 v[20:23], v11 offset:4096
    s_waitcnt lgkmcnt(2)
    v_mfma_f32_32x32x16_bf16 v[128:143], v[32:35], v[6:9], v[128:143]
    v_max3_u32 v162, v162, v6, v7
    v_max3_u32 v162, v162, v8, v9
    ds_read_b128 v[6:9], v11 offset:5120
    s_waitcnt lgkmcnt(2)
    v_mfma_f32_32x32x16_bf16 v[128:143], v[36:39], v[16:19], v[128:143]
    v_max3_u32 v162, v162, v16, v17
    v_max3_u32 v162, v162, v18, v19
    ds_read_b128 v[16:19], v11 offset:6144
    s_waitcnt lgkmcnt(2)
    v_mfma_f32_32x32x16_bf16 v[128:143], v[40:43], v[20:23], v[128:143]
    v_max3_u32 v162, v162, v20, v21
    v_max3_u32 v162, v162, v22, v23
    ds_read_b128 v[20:23], v11 offset:7168
    s_waitcnt lgkmcnt(2)
    v_mfma_f32_32x32x16_bf16 v[128:143], v[44:47], v[6:9], v[128:143]
    v_max3_u32 v162, v162, v6, v7
    v_max3_u32 v162, v162, v8, v9
    ds_read_b128 v[6:9], v11 offset:8192
    s_waitcnt lgkmcnt(2)
    v_mfma_f32_32x32x16_bf16 v[128:143], v[48:51], v[16:19], v[128:143]
    v_max3_u32 v162, v162, v16, v17
    v_max3_u32 v162, v162, v18, v19
    ds_read_b128 v[16:19], v11 offset:9216
    s_waitcnt lgkmcnt(2)
    v_mfma_f32_32x32x16_bf16 v[128:143], v[52:55], v[20:23], v[128:143]
    v_max3_u32 v162, v162, v20, v21
    v_max3_u32 v162, v162, v22, v23
    ds_read_b128 v[20:23], v11 offset:10240
    s_waitcnt lgkmcnt(2)
    v_mfma_f32_32x32x16_bf16 v[128:143], v[56:59], v[6:9], v[128:143]
    v_max3_u32 v162, v162, v6, v7
    v_max3_u32 v162, v162, v8, v9
    ds_read_b128 v[6:9], v11 offset:11264
    s_waitcnt lgkmcnt(2)
    v_mfma_f32_32x32x16_bf16 v[128:143], v[60:63], v[16:19], v[128:143]
    v_max3_u32 v162, v162, v16, v17
    v_max3_u32 v162, v162, v18, v19
    ds_read_b128 v[16:19], v11 offset:12288
    s_waitcnt lgkmcnt(2)
    v_mfma_f32_32x32x16_bf16 v[128:143], v[64:67], v[20:23], v[128:143]
    v_max3_u32 v162, v162, v20, v21
    v_max3_u32 v162, v162, v22, v23
    ds_read_b128 v[20:23], v11 offset:13312
    s_waitcnt lgkmcnt(2)
    v_mfma_f32_32x32x16_bf16 v[128:143], v[68:71], v[6:9], v[128:143]
    v_max3_u32 v162, v162, v6, v7
    v_max3_u32 v162, v162, v8, v9
    ds_read_b128 v[6:9], v11 offset:14336
    s_waitcnt lgkmcnt(2)
    v_mfma_f32_32x32x16_bf16 v[128:143], v[72:75], v[16:19], v[128:143]
    v_max3_u32 v162, v162, v16, v17
    v_max3_u32 v162, v162, v18, v19
    ds_read_b128 v[16:19], v11 offset:15360
    s_waitcnt lgkmcnt(2)
    v_mfma_f32_32x32x16_bf16 v[128:143], v[76:79], v[20:23], v[128:143]
    v_max3_u32 v162, v162, v20, v21
    v_max3_u32 v162, v162, v22, v23
    ds_read_b128 v[20:23], v11 offset:16384
    s_waitcnt lgkmcnt(2)
    v_mfma_f32_32x32x16_bf16 v[128:143], v[80:83], v[6:9], v[128:143]
    v_max3_u32 v162, v162, v6, v7
    v_max3_u32 v162, v162, v8, v9
    ds_read_b128 v[6:9], v11 offset:17408
    s_waitcnt lgkmcnt(2)
    v_mfma_f32_32x32x16_bf16 v[128:143], v[84:87], v[16:19], v[128:143]
    v_max3_u32 v162, v162, v16, v17
    v_max3_u32 v162, v162, v18, v19
    ds_read_b128 v[16:19], v11 offset:18432
    s_waitcnt lgkmcnt(2)
    v_mfma_f32_32x32x16_bf16 v[128:143], v[88:91], v[20:23], v[128:143]
    v_max3_u32 v162, v162, v20, v21
    v_max3_u32 v162, v162, v22, v23
    ds_read_b128 v[20:23], v11 offset:19456
    s_waitcnt lgkmcnt(2)
    v_mfma_f32_32x32x16_bf16 v[128:143], v[92:95], v[6:9], v[128:143]
    v_max3_u32 v162, v162, v6, v7
    v_max3_u32 v162, v162, v8, v9
    ds_read_b128 v[6:9], v11 offset:20480
    s_waitcnt lgkmcnt(2)
    v_mfma_f32_32x32x16_bf16 v[128:143], v[96:99], v[16:19], v[128:143]
    v_max3_u32 v162, v162, v16, v17
    v_max3_u32 v162, v162, v18, v19
    ds_read_b128 v[16:19], v11 offset:21504
    s_waitcnt lgkmcnt(2)
    v_mfma_f32_32x32x16_bf16 v[128:143], v[100:103], v[20:23], v[128:143]
    v_max3_u32 v162, v162, v20, v21
    v_max3_u32 v162, v162, v22, v23
    ds_read_b128 v[20:23], v11 offset:22528
    s_waitcnt lgkmcnt(2)
    v_mfma_f32_32x32x16_bf16 v[128:143], v[104:107], v[6:9], v[128:143]
    v_max3_u32 v162, v162, v6, v7
    v_max3_u32 v162, v162, v8, v9
    ds_read_b128 v[6:9], v11 offset:23552
    s_waitcnt lgkmcnt(2)
    v_mfma_f32_32x32x16_bf16 v[128:143], v[108:111], v[16:19], v[128:143]
    v_max3_u32 v162, v162, v16, v17
    v_max3_u32 v162, v162, v18, v19
    ds_read_b128 v[16:19], v11 offset:24576
    s_waitcnt lgkmcnt(2)
    v_mfma_f32_32x32x16_bf16 v[128:143], v[112:115], v[20:23], v[128:143]
    v_max3_u32 v162, v162, v20, v21
    v_max3_u32 v162, v162, v22, v23
    ds_read_b128 v[20:23], v11 offset:25600
    s_waitcnt lgkmcnt(2)
    v_mfma_f32_32x32x16_bf16 v[128:143], v[116:119], v[6:9], v[128:143]
    v_max3_u32 v162, v162, v6, v7
    v_max3_u32 v162, v162, v8, v9
    ds_read_b128 v[6:9], v11 offset:26624
    s_waitcnt lgkmcnt(2)
    v_mfma_f32_32x32x16_bf16 v[128:143], v[120:123], v[16:19], v[128:143]
    v_max3_u32 v162, v162, v16, v17
    v_max3_u32 v162, v162, v18, v19
    ds_read_b128 v[16:19], v11 offset:27648
    s_waitcnt lgkmcnt(2)
    v_mfma_f32_32x32x16_bf16 v[128:143], v[124:127], v[20:23], v[128:143]
    v_max3_u32 v162, v162, v20, v21
    v_max3_u32 v162, v162, v22, v23
    ds_read_b128 v[20:23], v11 offset:28672
    s_waitcnt lgkmcnt(2)
    v_mfma_f32_32x32x16_bf16 v[128:143], v[164:167], v[6:9], v[128:143]
    v_max3_u32 v162, v162, v6, v7
    v_max3_u32 v162, v162, v8, v9
    ds_read_b64_tr_b16 v[164:165], v12 offset:4096
    ds_read_b64_tr_b16 v[166:167], v12 offset:4608
    ds_read_b128 v[6:9], v11 offset:29696
    s_waitcnt lgkmcnt(4)
    v_mfma_f32_32x32x16_bf16 v[128:143], v[0:3], v[16:19], v[128:143]
    v_max3_u32 v162, v162, v16, v17
    v_max3_u32 v162, v162, v18, v19
    ds_read_b64_tr_b16 v[0:1], v12 offset:5120
    ds_read_b64_tr_b16 v[2:3], v12 offset:5632
    ds_read_b128 v[16:19], v11 offset:30720
    s_waitcnt lgkmcnt(4)
    v_mfma_f32_32x32x16_bf16 v[128:143], v[164:167], v[20:23], v[128:143]
    v_max3_u32 v162, v162, v20, v21
    v_max3_u32 v162, v162, v22, v23
    ds_read_b64_tr_b16 v[164:165], v12 offset:0
    ds_read_b64_tr_b16 v[166:167], v12 offset:512
    ds_read_b128 v[20:23], v11 offset:31744
    s_waitcnt lgkmcnt(4)
    v_mfma_f32_32x32x16_bf16 v[128:143], v[0:3], v[6:9], v[128:143]
    v_max3_u32 v162, v162, v6, v7
    v_max3_u32 v162, v162, v8, v9
    ds_read_b64_tr_b16 v[0:1], v12 offset:1024
    ds_read_b64_tr_b16 v[2:3], v12 offset:1536
    s_waitcnt lgkmcnt(3)
    v_mfma_f32_32x32x16_bf16 v[128:143], v[164:167], v[16:19], v[128:143]
    v_max3_u32 v162, v162, v16, v17
    v_max3_u32 v162, v162, v18, v19
    s_waitcnt lgkmcnt(0)
    v_mfma_f32_32x32x16_bf16 v[128:143], v[0:3], v[20:23], v[128:143]
    v_max3_u32 v162, v162, v20, v21
    v_max3_u32 v162, v162, v22, v23
    v_cmp_eq_u32 vcc, -1, v162
    s_nop 0
    s_cmp_eq_u64 vcc, 0
    s_cbranch_scc1 L_fok
    s_add_u32 s64, s64, 1
    s_cmpk_ge_u32 s64, 8192
    s_cbranch_scc1 L_fok
    s_mov_b32 s65, 0
L_fr:
    s_add_u32 m0, s61, s65
    s_add_u32 s63, s14, s65
    buffer_load_dwordx4 v5, s[48:51], s63 offen offset:0 sc1 lds
    buffer_load_dwordx4 v5, s[48:51], s63 offen offset:1024 sc1 lds
    buffer_load_dwordx4 v5, s[48:51], s63 offen offset:2048 sc1 lds
    buffer_load_dwordx4 v5, s[48:51], s63 offen offset:3072 sc1 lds
    s_add_u32 s65, s65, 4096
    s_cmp_lt_u32 s65, 32768
    s_cbranch_scc1 L_fr
    s_waitcnt vmcnt(0)
    s_branch L_fm
L_fok:
    s_nop 5
    v_fma_f32 v144, v128, v14, v144
    v_fma_f32 v145, v129, v14, v145
    v_fma_f32 v146, v130, v14, v146
    v_fma_f32 v147, v131, v14, v147
    v_fma_f32 v148, v132, v14, v148
    v_fma_f32 v149, v133, v14, v149
    v_fma_f32 v150, v134, v14, v150
    v_fma_f32 v151, v135, v14, v151
    v_fma_f32 v152, v136, v14, v152
    v_fma_f32 v153, v137, v14, v153
    v_fma_f32 v154, v138, v14, v154
    v_fma_f32 v155, v139, v14, v155
    v_fma_f32 v156, v140, v14, v156
    v_fma_f32 v157, v141, v14, v157
    v_fma_f32 v158, v142, v14, v158
    v_fma_f32 v159, v143, v14, v159
    v_cvt_pk_bf16_f32 v24, v144, v145
    v_cvt_pk_bf16_f32 v25, v146, v147
    v_cvt_pk_bf16_f32 v26, v148, v149
    v_cvt_pk_bf16_f32 v27, v150, v151
    v_cvt_pk_bf16_f32 v28, v152, v153
    v_cvt_pk_bf16_f32 v29, v154, v155
    v_cvt_pk_bf16_f32 v30, v156, v157
    v_cvt_pk_bf16_f32 v31, v158, v159
    buffer_store_dwordx4 v[24:27], v10, s[56:59], s60 offen
    buffer_store_dwordx4 v[28:31], v10, s[56:59], s60 offen offset:16
    s_cmp_lg_u32 s2, 0
    s_cbranch_scc1 L_ne
    s_cmp_lg_u32 s3, 4
    s_cbranch_scc1 L_ne
    v_mov_b32 v16, s68
    v_mov_b32 v17, s69
    v_mov_b32 v18, 0
    s_mov_b32 s9, 11272192
    s_mov_b64 exec, 1
    buffer_store_dwordx2 v[16:17], v18, s[48:51], s9 offen sc1
    s_mov_b64 exec, -1
L_ne:
L_end:
    s_endpgm
.section .rodata,"a"
.p2align 6
.amdhsa_kernel gated_mix__softmax_full_mha__dense_activation_gelu__prompt_kernel
  .amdhsa_next_free_vgpr 168
  .amdhsa_next_free_sgpr 102
  .amdhsa_accum_offset 168
  .amdhsa_group_segment_fixed_size 0
  .amdhsa_kernarg_size 96
  .amdhsa_user_sgpr_count 2
  .amdhsa_user_sgpr_kernarg_segment_ptr 1
  .amdhsa_system_sgpr_workgroup_id_x 1
.end_amdhsa_kernel
```
